```python
import torch

def _softmax(x, axis=-1):
    return torch.softmax(x, dim=axis)
def _gelu(x):
    return torch.nn.functional.gelu(x, approximate="tanh")
def _silu(x):
    return torch.nn.functional.silu(x)
def _sigmoid(x):
    return torch.sigmoid(x)
def _layernorm(x, axis=-1, eps=1e-5):
    m = x.mean(dim=axis, keepdim=True)
    v = x.var(dim=axis, keepdim=True, unbiased=False)
    return (x - m) / torch.sqrt(v + eps)
def _scatter_add(tgt, idx, src, axis=0):
    return tgt.clone().index_add_(axis, idx, src)
def _segment_sum(src, seg, n):
    out = torch.zeros((n,) + src.shape[1:], dtype=src.dtype)
    return out.index_add_(0, seg, src)
def _pad(x, pw):
    flat = tuple(v for pair in reversed(pw) for v in pair)
    return torch.nn.functional.pad(x, flat)

kernel_name = 'sequential_preLN__ssm_conv_s4__dense_activation_relu__prompt'

def setup_inputs():

    _w = (lambda a: (lambda t: t.to(torch.bfloat16) if t.is_floating_point() else t)(torch.as_tensor(a)))
    def _A_setup():
        B, L, D, N = 1, 2048, 512, 128
        A_re = -(lambda _x: torch.exp(torch.as_tensor(_x)))((lambda *s: torch.randn(*s, dtype=torch.bfloat16) * 6.4)(D, N))
        A_im = torch.pi * (lambda *s: torch.randn(*s, dtype=torch.bfloat16) * 0.05)(D, N)
        B_re = (lambda *s: torch.randn(*s, dtype=torch.bfloat16) * 0.05)(D, N)
        B_im = (lambda *s: torch.randn(*s, dtype=torch.bfloat16) * 0.05)(D, N)
        C_re = (lambda *s: torch.randn(*s, dtype=torch.bfloat16) * 0.05)(D, N)
        C_im = (lambda *s: torch.randn(*s, dtype=torch.bfloat16) * 0.05)(D, N)
        log_dt = (lambda *s: torch.randn(*s, dtype=torch.bfloat16) * 0.05)(D) * 0.5 - 4.0
        Dskip = (lambda *s: torch.randn(*s, dtype=torch.bfloat16) * 0.05)(D)
        return {
            "u": _w((lambda *s: torch.randn(*s, dtype=torch.bfloat16) * 0.05)(B, L, D)),
            "A_re": _w(A_re),
            "A_im": _w(A_im),
            "B_re": _w(B_re),
            "B_im": _w(B_im),
            "C_re": _w(C_re),
            "C_im": _w(C_im),
            "log_dt": _w(log_dt),
            "Dskip": _w(Dskip),
        }
    _A_in = _A_setup()

    def _B_setup():
        B, S, D, Dff = 1, 2048, 512, 1792
        return {
            "x": _w((lambda *s: torch.randn(*s, dtype=torch.bfloat16) * 0.05)(B, S, D)),
            "w1": _w((lambda *s: torch.randn(*s, dtype=torch.bfloat16) * 0.05)(D, Dff)),
            "w2": _w((lambda *s: torch.randn(*s, dtype=torch.bfloat16) * 0.05)(Dff, D)),
        }
    _B_in = _B_setup()

    return {
        "A_u": _A_in["u"],
        "A_A_re": _A_in["A_re"],
        "A_A_im": _A_in["A_im"],
        "A_B_re": _A_in["B_re"],
        "A_B_im": _A_in["B_im"],
        "A_C_re": _A_in["C_re"],
        "A_C_im": _A_in["C_im"],
        "A_log_dt": _A_in["log_dt"],
        "A_Dskip": _A_in["Dskip"],
        "B_x": _B_in["x"],
        "B_w1": _B_in["w1"],
        "B_w2": _B_in["w2"],
    }

def reference(A_u, A_A_re, A_A_im, A_B_re, A_B_im, A_C_re, A_C_im, A_log_dt, A_Dskip, B_x, B_w1, B_w2):
    def _A_ref(u, A_re, A_im, B_re, B_im, C_re, C_im, log_dt, Dskip):
        Bsz, L, D = u.shape
        dt = torch.exp(log_dt)[:, None]
        A = A_re + 1j * A_im
        Bc = B_re + 1j * B_im
        Cc = C_re + 1j * C_im
        logdA = dt * A
        dB = dt * Bc
        l = (lambda x, dt: x.to(dt))(torch.arange(L), A_re.dtype)
        P = torch.exp(logdA[:, :, None] * l[None, None, :])
        K = torch.einsum("dn,dnl,dn->dl", Cc, P, dB).real
        L2 = 2 * L
        Kp = _pad(K, ((0, 0), (0, L)))
        up = (lambda x, *d: x.permute(*d))(u, 0, 2, 1)
        up = _pad(up, ((0, 0), (0, 0), (0, L)))
        Kf = (lambda x, axes=(-2,-1): torch.fft.rfft2(x.float(), dim=axes))(Kp[:, None, :], axes=(-2, -1))
        Uf = (lambda x, axes=(-2,-1): torch.fft.rfft2(x.float(), dim=axes))(up[:, :, None, :], axes=(-2, -1))
        Yf = Uf * Kf[None, :, :, :]
        y = (lambda x, s, axes=(-2,-1): torch.fft.irfft2(x, s=s, dim=axes).to(torch.bfloat16))(Yf, (1, L2), axes=(-2, -1))[:, :, 0, :L]
        y = (lambda x, *d: x.permute(*d))(y, 0, 2, 1) + u * Dskip[None, None, :]
        return y

    def _B_ref(x, w1, w2):
        h = torch.einsum("bsd,df->bsf", x, w1)
        zero = torch.zeros_like(h)
        h = torch.maximum(h, zero)
        return torch.einsum("bsf,fd->bsd", h, w2)

    x = A_u
    h = x + _A_ref(_layernorm(x, axis=-1), A_A_re, A_A_im, A_B_re, A_B_im, A_C_re, A_C_im, A_log_dt, A_Dskip)
    h2 = h + _B_ref(_layernorm(h, axis=-1), B_w1, B_w2)
    return h2
```

```asm
; @launch grid=(256,1,1) block=(256,1,1) lds=163840
.amdgcn_target "amdgcn-amd-amdhsa--gfx950"
.text
.globl sequential_preLN__ssm_conv_s4__dense_activation_relu__prompt_kernel
.p2align 8
.type sequential_preLN__ssm_conv_s4__dense_activation_relu__prompt_kernel,@function
sequential_preLN__ssm_conv_s4__dense_activation_relu__prompt_kernel:
L_CODE_BEGIN:
    s_cmp_ge_u32 s2, 256
    s_cbranch_scc1 L_END
    s_load_dwordx16 s[16:31], s[0:1], 0
    s_getpc_b64 s[10:11]
    s_bfe_u32 s64, s2, 0x30003
    v_and_or_b32 v3, v0, -8, s64
    v_lshlrev_b32_e64 v3, 7, v3
    v_min_u32 v3, L_CODE_END-L_CODE_BEGIN-64, v3
    global_load_dword v34, v3, s[10:11]
    s_load_dwordx2 s[44:45], s[0:1], 112
    s_load_dwordx8 s[32:39], s[0:1], 64
    s_load_dwordx4 s[40:43], s[0:1], 96
    s_lshl_b32 s64, s2, 13
    v_and_b32 v2, 31, v0
    v_add_u32 v2, v2, v0
    v_and_b32 v1, 0xe0, v0
    v_lshlrev_b32 v2, 3, v2
    v_mad_u32_u24 v2, v1, 24, v2
    v_and_b32_e64 v3, 3, v0
    v_mul_u32_u24 v3, 0x7fc, v3
    v_lshl_add_u32 v3, v0, 2, v3
    s_waitcnt lgkmcnt(0)
    s_load_dword s4, s[44:45], 32768
    s_add_u32 s66, s16, s64
    s_addc_u32 s67, s17, 0
    global_load_dwordx4 v[4:7], v2, s[66:67]
    global_load_dwordx4 v[8:11], v2, s[66:67] offset:512
    global_load_dwordx4 v[200:203], v3, s[66:67]
    s_nop 0
    global_load_dwordx4 v[204:207], v3, s[66:67] offset:1024
    v_lshrrev_b32_e64 v1, 6, v0
    s_lshr_b32 s48, s2, 3
    v_readfirstlane_b32 s46, v1
    s_and_b32 s47, s2, 7
    s_lshl_b32 s49, s47, 6
    s_lshl_b32 s65, s48, 1
    s_add_u32 s49, s49, s65
    s_lshl_b32 s65, s49, 8
    v_lshl_add_u32 v36, v0, 1, s65
    s_lshl_b32 s65, s49, 1
    global_load_ushort v28, v36, s[18:19]
    global_load_ushort v29, v36, s[20:21]
    global_load_ushort v30, v36, s[22:23]
    global_load_ushort v31, v36, s[24:25]
    global_load_ushort v32, v36, s[26:27]
    global_load_ushort v33, v36, s[28:29]
    s_load_dword s5, s[30:31], s65
    s_load_dword s6, s[32:33], s65
    s_lshl_b32 s64, s2, 6
    s_lshl_b32 s65, s2, 6
    s_add_u32 s65, s65, 131072
    s_cmp_eq_u32 s46, 2
    s_cselect_b32 s64, s65, s64
    s_lshl_b32 s65, s49, 3
    s_add_u32 s65, s65, 45056
    s_cmp_eq_u32 s46, 3
    s_cselect_b32 s64, s65, s64
    s_load_dword s12, s[44:45], s64
    s_lshl_b32 s64, s2, 2
    s_add_u32 s64, s64, s46
    s_mul_i32 s64, s64, 1792
    v_and_b32 v3, 15, v0
    v_min_u32 v3, 13, v3
    v_lshl_add_u32 v3, v3, 7, s64
    s_mov_b64 exec, 0xffff
    global_load_dword v34, v3, s[36:37]
    s_mov_b64 exec, -1
    v_mov_b32 v255, v3
    v_and_b32 v2, 63, v0
    v_lshlrev_b32 v252, 4, v2
    s_lshr_b32 s9, s46, 1
    s_and_b32 s13, s46, 1
    s_add_u32 s65, s49, s9
    s_lshl_b32 s65, s65, 12
    s_lshl_b32 s66, s13, 9
    s_add_u32 s65, s65, s66
    s_add_u32 s65, s65, 1048576
    v_and_b32 v228, 15, v0
    v_lshl_add_u32 v228, v228, 4, s65
    v_bfe_u32 v3, v0, 5, 1
    v_lshl_add_u32 v228, v3, 8, v228
    v_bfe_u32 v3, v0, 4, 1
    v_lshl_add_u32 v228, v3, 10, v228
    v_mov_b32 v232, -1
    v_mov_b32 v233, -1
    v_mov_b32 v234, -1
    v_mov_b32 v235, -1
    s_lshl_b32 s50, s47, 2
    s_lshr_b32 s64, s48, 3
    s_add_u32 s50, s50, s64
    s_and_b32 s51, s48, 7
    s_lshl_b32 s7, s2, 2
    s_add_u32 s7, s7, s46
    s_mov_b32 s8, 0
    s_mov_b32 s52, s36
    s_mov_b32 s53, s37
    s_mov_b32 s54, 1835008
    s_mov_b32 s55, 0x20000
    s_and_b32 s64, s51, 1
    s_lshl_b32 s3, s46, 1
    s_add_u32 s3, s3, s64
    s_cmp_eq_u32 s3, 7
    s_cselect_b32 s3, 0, s3
    s_mul_i32 s14, s51, 448
    s_lshl_b32 s64, s3, 6
    s_add_u32 s14, s14, s64
    s_lshl_b32 s60, s46, 14
    s_add_u32 s60, s60, 98304
    s_lshl_b32 s61, s46, 13
    s_add_u32 s61, s61, 65536
    v_bfe_u32 v248, v0, 3, 3
    v_lshlrev_b32 v249, 2, v3
    v_xor_b32 v249, v249, v0
    v_and_b32 v249, 7, v249
    v_lshlrev_b32 v249, 4, v249
    v_mul_u32_u24 v240, 3584, v248
    v_add_u32 v240, v240, v249
    s_cmp_eq_u32 s46, 3
    s_cselect_b32 s64, 64, 0
    v_and_b32 v37, s64, v249
    v_lshl_add_u32 v240, v37, 24, v240
    v_add_u32 v241, 27648, v240
    v_add_u32 v242, 55296, v240
    v_add_u32 v243, 82944, v240
    s_add_u32 m0, s60, 0
    s_add_u32 s15, s14, 0
    buffer_load_dwordx4 v240, s[52:55], s15 offen offset:0  lds
    s_getreg_b32 s101, hwreg(HW_REG_XCC_ID)
    s_add_u32 s56, s44, 1048576
    s_addc_u32 s57, s45, 0
    s_mov_b32 s58, 2097152
    s_mov_b32 s59, 0x20000
    s_lshl_b32 s64, s2, 6
    s_nop 0
    s_add_u32 s65, s64, 4194304
    v_and_b32 v35, 0xfc, v0
    v_mul_u32_u24 v35, 28672, v35
    v_and_b32 v3, 3, v0
    v_lshl_add_u32 v3, v3, 4, s65
    v_add_u32 v224, v3, v35
    v_add_u32 v225, 28672, v224
    v_add_u32 v226, 57344, v224
    v_add_u32 v227, 86016, v224
    v_lshrrev_b32 v2, 6, v0
    v_lshl_add_u32 v2, v2, 4, s64
    v_bfe_u32 v250, v0, 5, 1
    v_lshlrev_b32 v250, 9, v250
    v_bfe_u32 v1, v0, 2, 2
    v_lshl_add_u32 v250, v1, 7, v250
    buffer_load_dwordx4 v241, s[52:55], s15 offen offset:1024  lds
    v_bfe_u32 v1, v0, 3, 1
    v_lshl_add_u32 v250, v1, 6, v250
    v_bfe_u32 v1, v0, 4, 1
    v_lshl_add_u32 v250, v1, 5, v250
    v_and_b32 v1, 3, v0
    v_lshl_add_u32 v250, v1, 3, v250
    v_xor_b32 v251, 64, v250
    v_add_u32 v244, s60, v250
    v_add_u32 v246, s61, v250
    v_add_u32 v245, s60, v251
    v_add_u32 v247, s61, v251
    s_mul_i32 s66, s9, 6208
    s_add_u32 s66, s66, 65568
    v_and_b32 v60, 15, v0
    v_lshl_add_u32 v61, v60, 5, s66
    v_bfe_u32 v62, v0, 4, 2
    buffer_load_dwordx4 v242, s[52:55], s15 offen offset:2048  lds
    v_lshl_add_u32 v56, v62, 10, v61
    v_cmp_gt_u32 vcc, 2, v62
    v_lshlrev_b32 v63, 9, v62
    v_lshlrev_b32 v64, 4, v62
    v_add_u32 v64, 512, v64
    v_cndmask_b32_e64 v63, v63, v64, vcc
    v_cndmask_b32_e64 v64, 8, 4, vcc
    s_cmp_eq_u32 s13, 1
    s_cselect_b64 s[70:71], -1, 0
    v_lshlrev_b32 v65, 3, v62
    v_cndmask_b32 v63, v65, v63, s[70:71]
    v_cndmask_b32 v64, 2, v64, s[70:71]
    v_add_u32 v52, v61, v63
    v_add_u32 v53, v52, v64
    v_add_u32 v54, v53, v64
    v_add_u32_e64 v55, v54, v64
    s_mul_i32 s65, s9, 31008
    v_mul_u32_u24 v57, 544, v60
    buffer_load_dwordx4 v243, s[52:55], s15 offen offset:3072  lds
    v_lshl_add_u32 v57, v62, 4, v57
    v_add_u32 v57, s65, v57
    s_mul_i32 s66, s13, 8704
    v_add_u32 v58, s66, v57
    v_mov_b32 v64, 0
    v_mov_b32 v65, 0
    v_mov_b32 v66, 0
    v_mov_b32 v67, 0
    v_and_b32_e64 v61, 1, v0
    v_bfe_u32 v63, v0, 1, 1
    v_mul_u32_u24 v63, 6208, v63
    v_lshl_add_u32 v61, v61, 4, v63
    v_add_u32 v61, 65536, v61
    s_mov_b64 exec, 15
    ds_write_b128 v61, v[64:67]
    s_mov_b64 exec, -1
    v_mov_b32 v1, 0x3f803f80
    v_mov_b32_e64 v210, s101
    s_add_u32 m0, s60, 4096
    s_add_u32 s15, s14, 114688
    buffer_load_dwordx4 v240, s[52:55], s15 offen offset:0  lds
    v_mov_b32 v214, s101
    v_mov_b32 v218, s101
    v_mov_b32 v222, s101
    v_and_b32 v60, 15, v0
    v_bfe_u32 v61, v0, 4, 3
    v_and_b32 v62, 7, v0
    v_cmp_gt_u32 vcc, 128, v0
    v_mov_b32 v63, 16
    v_lshlrev_b32 v68, 4, v60
    v_cndmask_b32 v61, v62, v61, vcc
    v_cndmask_b32_e64 v63, v63, v60, vcc
    v_mul_u32_u24 v61, 4384, v61
    v_lshl_add_u32 v61, v63, 4, v61
    v_add_u32 v61, 4128, v61
    v_bfe_u32 v62, v0, 4, 1
    buffer_load_dwordx4 v241, s[52:55], s15 offen offset:1024  lds
    v_mul_u32_u24 v62, 4352, v62
    v_cmp_gt_u32 vcc, 192, v0
    s_mov_b32 s67, 35104
    v_add3_u32 v62, v62, v68, s67
    s_nop 0
    v_cndmask_b32 v59, v62, v61, vcc
    v_and_b32 v60, 15, v0
    v_bfe_u32 v62, v0, 4, 2
    v_not_b32 v63, v0
    v_and_b32 v61, 3, v63
    v_mul_u32_u24 v196, 4384, v61
    v_and_b32 v61, 4, v63
    v_lshl_add_u32 v196, v61, 1, v196
    v_and_b32 v61, 8, v63
    v_lshl_add_u32 v196, v61, 5, v196
    v_lshl_add_u32 v196, v62, 4, v196
    s_mul_i32 s65, s9, 17536
    s_lshl_b32 s66, s13, 8
    s_sub_u32 s65, s65, s66
    s_add_u32 s65, s65, 288
    v_add_u32 v196, s65, v196
    buffer_load_dwordx4 v242, s[52:55], s15 offen offset:2048  lds
    v_add_u32 v197, v60, v62
    s_mul_i32 s65, s9, 4352
    s_add_u32 s65, s65, 35120
    s_sub_u32 s65, s65, s66
    v_lshl_add_u32 v197, v197, 4, s65
    s_lshl_b32 s65, s9, 13
    s_lshl_b32 s66, s13, 10
    s_add_u32 s65, s65, s66
    s_add_u32 s65, s65, 43808
    v_lshrrev_b32 v61, 1, v62
    v_lshl_add_u32 v61, v61, 8, s65
    v_lshl_add_u32 v61, v60, 4, v61
    v_and_b32 v63, 1, v62
    v_lshl_add_u32 v198, v63, 3, v61
    v_add_u32 v199, s65, v252
    s_lshl_b32 s66, s66, 1
    s_sub_u32 s65, s65, s66
    s_add_u32 s65, s65, 1024
    v_add_u32 v254, s65, v252
    v_and_b32 v231, 2, v0
    v_and_b32 v61, 3, v0
    v_add_u32 v231, v231, v61
    v_mul_u32_u24 v231, 4384, v231
    v_add_u32 v231, 12892, v231
    buffer_load_dwordx4 v243, s[52:55], s15 offen offset:3072  lds
    s_mul_i32 s64, s49, 14336
    s_add_u32 s64, s64, 4198400
    v_lshl_add_u32 v192, v0, 4, s64
    v_add_u32 v193, 8192, v192
    v_lshlrev_b32_e64 v194, 4, v0
    v_add_u32 v194, 4096, v194
    v_add_u32 v195, 8192, v194
    v_lshlrev_b32 v35, 1, v0
    v_sub_u32 v35, 2047, v35
    v_cvt_f32_i32 v35, v35
    s_mov_b32 s64, 65568
    v_add_f32 v40, 0x80000000, v35
    v_add_f32 v41, 0xbf800000, v35
    v_cvt_pk_bf16_f32 v40, v40, v41
    v_and_b32 v41, 0xffff0000, v40
    v_lshlrev_b32 v40, 16, v40
    v_cvt_i32_f32 v40, v40
    s_add_u32 m0, s60, 8192
    s_add_u32 s15, s14, 229376
    buffer_load_dwordx4 v240, s[52:55], s15 offen offset:0  lds
    v_cvt_i32_f32 v41, v41
    v_lshl_add_u32 v40, v40, 1, s64
    v_lshl_add_u32 v41, v41, 1, s64
    v_add_f32_e64 v42, 0xc0000000, v35
    v_add_f32 v43, 0xc4000000, v35
    v_cvt_pk_bf16_f32 v42, v42, v43
    v_and_b32 v43, 0xffff0000, v42
    v_lshlrev_b32 v42, 16, v42
    v_cvt_i32_f32 v42, v42
    v_cvt_i32_f32_e64 v43, v43
    v_lshl_add_u32 v42, v42, 1, s64
    v_lshl_add_u32 v43, v43, 1, s64
    v_add_f32 v44, 0xc4004000, v35
    v_add_f32 v45, 0xc4008000, v35
    buffer_load_dwordx4 v241, s[52:55], s15 offen offset:1024  lds
    v_cvt_pk_bf16_f32 v44, v44, v45
    v_and_b32 v45, 0xffff0000, v44
    v_lshlrev_b32 v44, 16, v44
    v_cvt_i32_f32 v44, v44
    v_cvt_i32_f32_e64 v45, v45
    v_lshl_add_u32 v44, v44, 1, s64
    v_lshl_add_u32 v45, v45, 1, s64
    v_add_f32 v46, 0xc4800000, v35
    v_add_f32 v47, 0xc4802000, v35
    v_cvt_pk_bf16_f32 v46, v46, v47
    v_and_b32 v47, 0xffff0000, v46
    v_lshlrev_b32 v46, 16, v46
    v_cvt_i32_f32 v46, v46
    v_cvt_i32_f32_e64 v47, v47
    buffer_load_dwordx4 v242, s[52:55], s15 offen offset:2048  lds
    v_lshl_add_u32 v46, v46, 1, s64
    v_lshl_add_u32 v47, v47, 1, s64
    v_add_f32 v48, 0xc4804000, v35
    v_add_f32 v49, 0xc4c00000, v35
    v_cvt_pk_bf16_f32 v48, v48, v49
    v_and_b32 v49, 0xffff0000, v48
    v_lshlrev_b32 v48, 16, v48
    v_cvt_i32_f32 v48, v48
    v_cvt_i32_f32_e64 v49, v49
    v_lshl_add_u32 v48, v48, 1, s64
    v_lshl_add_u32 v49, v49, 1, s64
    v_add_f32 v50, 0xc4c02000, v35
    v_add_f32 v51, 0xc4c04000, v35
    v_cvt_pk_bf16_f32 v50, v50, v51
    buffer_load_dwordx4 v243, s[52:55], s15 offen offset:3072  lds
    v_and_b32 v51, 0xffff0000, v50
    v_lshlrev_b32 v50, 16, v50
    v_cvt_i32_f32 v50, v50
    v_cvt_i32_f32_e64 v51, v51
    v_lshl_add_u32 v50, v50, 1, s64
    v_lshl_add_u32 v51, v51, 1, s64
    s_waitcnt vmcnt(19)
    v_mov_b32 v208, v200
    v_mov_b32 v209, v204
    v_mov_b32 v212, v201
    v_mov_b32 v213, v205
    v_mov_b32 v216, v202
    v_mov_b32 v217, v206
    v_mov_b32 v220, v203
    v_mov_b32_e64 v221, v207
    v_dot2_f32_bf16 v12, v4, v1, 0
    v_dot2_f32_bf16 v13, v4, v4, 0
    v_dot2_f32_bf16 v12, v5, v1, v12
    v_dot2_f32_bf16 v13, v5, v5, v13
    v_dot2_f32_bf16 v12, v6, v1, v12
    v_dot2_f32_bf16 v13, v6, v6, v13
    v_dot2_f32_bf16 v12, v7, v1, v12
    v_dot2_f32_bf16 v13, v7, v7, v13
    v_dot2_f32_bf16 v12, v8, v1, v12
    v_dot2_f32_bf16 v13, v8, v8, v13
    v_dot2_f32_bf16 v12, v9, v1, v12
    v_dot2_f32_bf16 v13, v9, v9, v13
    v_dot2_f32_bf16 v12, v10, v1, v12
    v_dot2_f32_bf16 v13, v10, v10, v13
    v_dot2_f32_bf16 v12, v11, v1, v12
    v_dot2_f32_bf16 v13, v11, v11, v13
    s_nop 2
    v_add_f32_dpp v12, v12, v12 quad_perm:[1,0,3,2] row_mask:0xf bank_mask:0xf
    s_nop 0
    v_add_f32_dpp v13, v13, v13 quad_perm:[1,0,3,2] row_mask:0xf bank_mask:0xf
    s_nop 0
    v_add_f32_dpp v12, v12, v12 quad_perm:[2,3,0,1] row_mask:0xf bank_mask:0xf
    v_add_f32_dpp v13, v13, v13 quad_perm:[2,3,0,1] row_mask:0xf bank_mask:0xf
    s_nop 0
    v_add_f32_dpp v12, v12, v12 row_half_mirror row_mask:0xf bank_mask:0xf
    v_add_f32_dpp v13, v13, v13 row_half_mirror row_mask:0xf bank_mask:0xf
    s_nop 0
    v_add_f32_dpp v12, v12, v12 row_mirror row_mask:0xf bank_mask:0xf
    s_nop 0
    v_add_f32_dpp v13, v13, v13 row_mirror row_mask:0xf bank_mask:0xf
    s_nop 0
    v_add_f32_dpp v12, v12, v12 row_bcast:15 row_mask:0xa bank_mask:0xf
    v_add_f32_dpp v13, v13, v13 row_bcast:15 row_mask:0xa bank_mask:0xf
    v_mul_f32 v12, 0x3b000000, v12
    v_mul_f32 v13, 0x3b000000, v13
    v_fma_f32 v13, -v12, v12, v13
    v_max_f32 v13, 0, v13
    v_cvt_pk_bf16_f32 v12, v12, v13
    v_and_b32 v17, 0xffff0000, v12
    v_add_f32 v17, 0x3727c5ac, v17
    v_cvt_pk_bf16_f32 v17, v17, v17
    v_and_b32 v17, 0xffff0000, v17
    v_sqrt_f32 v17, v17
    v_lshlrev_b32 v12, 16, v12
    v_cvt_pk_bf16_f32 v17, v17, v17
    v_and_b32 v17, 0xffff0000, v17
    v_rcp_f32 v20, v17
    s_nop 0
    v_mul_f32 v18, v12, v20
    v_mov_b32 v21, v20
    v_mov_b32 v19, v18
    s_nop 0
    v_permlane32_swap_b32 v20, v21
    v_permlane32_swap_b32 v18, v19
    v_cvt_pk_bf16_f32 v22, -v18, -v19
    s_waitcnt lgkmcnt(0)
    s_add_u32 s4, s4, 0x1e3779b9
    s_bitset1_b32 s4, 31
    v_mov_b32 v211, s4
    v_mov_b32 v215, s4
    v_mov_b32 v219, s4
    v_mov_b32 v223, s4
    v_mov_b32 v23, s4
    s_mov_b64 exec, 0x10000
    global_store_dwordx4 v2, v[20:23], s[44:45] sc1
    s_mov_b64 exec, -1
    global_store_dwordx4 v224, v[208:211], s[44:45] sc1
    global_store_dwordx4 v225, v[212:215], s[44:45] sc1
    s_lshl_b32 s64, s9, 4
    s_lshr_b32 s67, s5, s64
    s_lshl_b32 s67, s67, 16
    s_lshl_b32 s68, s6, 16
    s_and_b32 s69, s6, 0xffff0000
    v_mov_b32 v39, 0x3fb8aa3b
    v_mul_f32 v38, s67, v39
    v_exp_f32 v38, v38
    s_nop 0
    v_cvt_pk_bf16_f32 v38, v38, v38
    v_and_b32 v38, 0xffff0000, v38
    s_waitcnt vmcnt(16)
    v_lshlrev_b32 v28, 16, v28
    v_lshlrev_b32 v29, 16, v29
    v_lshlrev_b32 v30, 16, v30
    v_lshlrev_b32 v31, 16, v31
    v_lshlrev_b32 v32, 16, v32
    v_lshlrev_b32 v33, 16, v33
    v_mul_f32 v28, v38, v28
    v_mul_f32 v29, v38, v29
    v_mul_f32 v30, v38, v30
    global_store_dwordx4 v226, v[216:219], s[44:45] sc1
    v_mul_f32 v31, v38, v31
    v_mul_f32 v28, v39, v28
    v_mul_f32 v29, 0.15915494, v29
    s_mul_i32 s64, s9, 31008
    s_lshl_b32 s67, s13, 8
    s_add_u32 s67, s64, s67
    v_mul_f32 v4, 0x41800000, v28
    v_mul_f32 v5, 0x41800000, v29
    v_mul_f32 v6, 0x43800000, v28
    v_mul_f32 v7, 0x43800000, v29
    v_exp_f32 v24, v28
    v_cos_f32 v62, v29
    v_sin_f32 v63, v29
    v_exp_f32 v25, v4
    v_cos_f32 v92, v5
    v_sin_f32 v93, v5
    v_exp_f32 v26, v6
    global_store_dwordx4 v227, v[220:223], s[44:45] sc1
    v_cos_f32 v98, v7
    v_sin_f32_e64 v99, v7
    v_pk_mul_f32 v[114:115], v[32:33], v[30:31] op_sel:[0,0] op_sel_hi:[0,1]
    v_pk_fma_f32 v[114:115], v[32:33], v[30:31], v[114:115] op_sel:[1,1,0] op_sel_hi:[1,0,1] neg_lo:[1,0,0]
    v_mul_f32 v62, v24, v62
    v_mul_f32 v63, v24, v63
    v_mul_f32 v92, v25, v92
    v_mul_f32 v93, v25, v93
    v_mul_f32 v98, v26, v98
    v_mul_f32 v99, v26, v99
    v_mov_b32 v127, 0x3f80
    v_pk_mul_f32 v[116:117], v[114:115], v[92:93] op_sel:[0,0] op_sel_hi:[0,1]
    v_pk_fma_f32 v[116:117], v[114:115], v[92:93], v[116:117] op_sel:[1,1,0] op_sel_hi:[1,0,1] neg_lo:[1,0,0]
    v_pk_mul_f32 v[94:95], v[92:93], v[92:93] op_sel:[0,0] op_sel_hi:[0,1]
    s_mov_b64 exec, 0xffff
    global_load_dword v253, v255, s[38:39]
    s_mov_b64 exec, -1
    v_pk_fma_f32 v[94:95], v[92:93], v[92:93], v[94:95] op_sel:[1,1,0] op_sel_hi:[1,0,1] neg_lo:[1,0,0]
    v_cvt_pk_bf16_f32 v128, v62, v63
    v_cvt_pk_bf16_f32 v129, v114, -v115
    v_cvt_pk_bf16_f32 v130, v98, v99
    s_nop 0
    v_cvt_pk_bf16_f32 v131, v116, -v117
    v_pk_mul_f32 v[64:65], v[62:63], v[62:63] op_sel:[0,0] op_sel_hi:[0,1]
    v_pk_fma_f32 v[64:65], v[62:63], v[62:63], v[64:65] op_sel:[1,1,0] op_sel_hi:[1,0,1] neg_lo:[1,0,0]
    v_pk_mul_f32 v[118:119], v[114:115], v[94:95] op_sel:[0,0] op_sel_hi:[0,1]
    v_pk_fma_f32 v[118:119], v[114:115], v[94:95], v[118:119] op_sel:[1,1,0] op_sel_hi:[1,0,1] neg_lo:[1,0,0]
    v_pk_mul_f32 v[100:101], v[98:99], v[98:99] op_sel:[0,0] op_sel_hi:[0,1]
    v_pk_fma_f32 v[100:101], v[98:99], v[98:99], v[100:101] op_sel:[1,1,0] op_sel_hi:[1,0,1] neg_lo:[1,0,0]
    v_cvt_pk_bf16_f32 v132, v64, v65
    v_cvt_pk_bf16_f32 v133, v118, -v119
    v_cvt_pk_bf16_f32 v134, v100, v101
    v_pk_mul_f32 v[66:67], v[62:63], v[64:65] op_sel:[0,0] op_sel_hi:[0,1]
    v_pk_fma_f32 v[66:67], v[62:63], v[64:65], v[66:67] op_sel:[1,1,0] op_sel_hi:[1,0,1] neg_lo:[1,0,0]
    v_pk_mul_f32 v[120:121], v[116:117], v[94:95] op_sel:[0,0] op_sel_hi:[0,1]
    v_pk_fma_f32 v[120:121], v[116:117], v[94:95], v[120:121] op_sel:[1,1,0] op_sel_hi:[1,0,1] neg_lo:[1,0,0]
    v_pk_mul_f32 v[102:103], v[98:99], v[100:101] op_sel:[0,0] op_sel_hi:[0,1]
    v_pk_fma_f32 v[102:103], v[98:99], v[100:101], v[102:103] op_sel:[1,1,0] op_sel_hi:[1,0,1] neg_lo:[1,0,0]
    v_cvt_pk_bf16_f32 v135, v66, v67
    v_cvt_pk_bf16_f32 v136, v120, -v121
    v_cvt_pk_bf16_f32 v137, v102, v103
    v_pk_mul_f32 v[68:69], v[64:65], v[64:65] op_sel:[0,0] op_sel_hi:[0,1]
    v_pk_fma_f32 v[68:69], v[64:65], v[64:65], v[68:69] op_sel:[1,1,0] op_sel_hi:[1,0,1] neg_lo:[1,0,0]
    v_pk_mul_f32 v[114:115], v[118:119], v[94:95] op_sel:[0,0] op_sel_hi:[0,1]
    v_pk_fma_f32 v[114:115], v[118:119], v[94:95], v[114:115] op_sel:[1,1,0] op_sel_hi:[1,0,1] neg_lo:[1,0,0]
    v_pk_mul_f32 v[104:105], v[100:101], v[100:101] op_sel:[0,0] op_sel_hi:[0,1]
    v_pk_fma_f32 v[104:105], v[100:101], v[100:101], v[104:105] op_sel:[1,1,0] op_sel_hi:[1,0,1] neg_lo:[1,0,0]
    v_cvt_pk_bf16_f32 v138, v68, v69
    v_cvt_pk_bf16_f32 v139, v114, -v115
    v_cvt_pk_bf16_f32 v140, v104, v105
    v_pk_mul_f32 v[70:71], v[64:65], v[66:67] op_sel:[0,0] op_sel_hi:[0,1]
    v_pk_fma_f32 v[70:71], v[64:65], v[66:67], v[70:71] op_sel:[1,1,0] op_sel_hi:[1,0,1] neg_lo:[1,0,0]
    v_pk_mul_f32 v[116:117], v[120:121], v[94:95] op_sel:[0,0] op_sel_hi:[0,1]
    v_pk_fma_f32 v[116:117], v[120:121], v[94:95], v[116:117] op_sel:[1,1,0] op_sel_hi:[1,0,1] neg_lo:[1,0,0]
    v_pk_mul_f32 v[106:107], v[100:101], v[102:103] op_sel:[0,0] op_sel_hi:[0,1]
    v_pk_fma_f32 v[106:107], v[100:101], v[102:103], v[106:107] op_sel:[1,1,0] op_sel_hi:[1,0,1] neg_lo:[1,0,0]
    v_cvt_pk_bf16_f32 v141, v70, v71
    s_mov_b32 m0, s67
    s_nop 0
    ds_write_addtid_b32 v127 offset:0
    ds_write_addtid_b32 v128 offset:544
    ds_write_addtid_b32 v129 offset:22304
    ds_write_addtid_b32 v130 offset:8704
    ds_write_addtid_b32 v131 offset:22848
    ds_write_addtid_b32 v132 offset:1088
    ds_write_addtid_b32 v133 offset:23392
    ds_write_addtid_b32 v134 offset:13056
    ds_write_addtid_b32 v135 offset:1632
    ds_write_addtid_b32 v136 offset:23936
    ds_write_addtid_b32 v137 offset:15232
    ds_write_addtid_b32 v138 offset:2176
    ds_write_addtid_b32 v139 offset:24480
    ds_write_addtid_b32 v140 offset:17408
    ds_write_addtid_b32 v141 offset:2720
    v_cvt_pk_bf16_f32 v142, v116, -v117
    v_cvt_pk_bf16_f32 v143, v106, v107
    v_pk_mul_f32 v[72:73], v[66:67], v[66:67] op_sel:[0,0] op_sel_hi:[0,1]
    v_pk_fma_f32 v[72:73], v[66:67], v[66:67], v[72:73] op_sel:[1,1,0] op_sel_hi:[1,0,1] neg_lo:[1,0,0]
    v_pk_mul_f32 v[118:119], v[114:115], v[94:95] op_sel:[0,0] op_sel_hi:[0,1]
    v_pk_fma_f32 v[118:119], v[114:115], v[94:95], v[118:119] op_sel:[1,1,0] op_sel_hi:[1,0,1] neg_lo:[1,0,0]
    v_pk_mul_f32 v[108:109], v[102:103], v[102:103] op_sel:[0,0] op_sel_hi:[0,1]
    v_pk_fma_f32 v[108:109], v[102:103], v[102:103], v[108:109] op_sel:[1,1,0] op_sel_hi:[1,0,1] neg_lo:[1,0,0]
    v_cvt_pk_bf16_f32 v144, v72, v73
    v_cvt_pk_bf16_f32 v145, v118, -v119
    v_cvt_pk_bf16_f32 v146, v108, v109
    v_pk_mul_f32 v[74:75], v[66:67], v[68:69] op_sel:[0,0] op_sel_hi:[0,1]
    v_pk_fma_f32 v[74:75], v[66:67], v[68:69], v[74:75] op_sel:[1,1,0] op_sel_hi:[1,0,1] neg_lo:[1,0,0]
    v_pk_mul_f32 v[120:121], v[116:117], v[94:95] op_sel:[0,0] op_sel_hi:[0,1]
    v_pk_fma_f32 v[120:121], v[116:117], v[94:95], v[120:121] op_sel:[1,1,0] op_sel_hi:[1,0,1] neg_lo:[1,0,0]
    v_pk_mul_f32 v[110:111], v[102:103], v[104:105] op_sel:[0,0] op_sel_hi:[0,1]
    v_pk_fma_f32 v[110:111], v[102:103], v[104:105], v[110:111] op_sel:[1,1,0] op_sel_hi:[1,0,1] neg_lo:[1,0,0]
    v_cvt_pk_bf16_f32 v147, v74, v75
    v_cvt_pk_bf16_f32 v148, v120, -v121
    v_cvt_pk_bf16_f32 v149, v110, v111
    v_pk_mul_f32 v[76:77], v[68:69], v[68:69] op_sel:[0,0] op_sel_hi:[0,1]
    v_pk_fma_f32 v[76:77], v[68:69], v[68:69], v[76:77] op_sel:[1,1,0] op_sel_hi:[1,0,1] neg_lo:[1,0,0]
    v_pk_mul_f32 v[114:115], v[118:119], v[94:95] op_sel:[0,0] op_sel_hi:[0,1]
    v_pk_fma_f32 v[114:115], v[118:119], v[94:95], v[114:115] op_sel:[1,1,0] op_sel_hi:[1,0,1] neg_lo:[1,0,0]
    v_pk_mul_f32 v[112:113], v[104:105], v[104:105] op_sel:[0,0] op_sel_hi:[0,1]
    v_pk_fma_f32 v[112:113], v[104:105], v[104:105], v[112:113] op_sel:[1,1,0] op_sel_hi:[1,0,1] neg_lo:[1,0,0]
    v_cvt_pk_bf16_f32 v150, v76, v77
    v_cvt_pk_bf16_f32 v151, v114, -v115
    v_cvt_pk_bf16_f32 v152, v112, v113
    v_pk_mul_f32 v[78:79], v[68:69], v[70:71] op_sel:[0,0] op_sel_hi:[0,1]
    v_pk_fma_f32 v[78:79], v[68:69], v[70:71], v[78:79] op_sel:[1,1,0] op_sel_hi:[1,0,1] neg_lo:[1,0,0]
    v_pk_mul_f32 v[116:117], v[120:121], v[94:95] op_sel:[0,0] op_sel_hi:[0,1]
    v_pk_fma_f32 v[116:117], v[120:121], v[94:95], v[116:117] op_sel:[1,1,0] op_sel_hi:[1,0,1] neg_lo:[1,0,0]
    v_cvt_pk_bf16_f32 v153, v78, v79
    v_cvt_pk_bf16_f32 v154, v116, -v117
    v_pk_mul_f32 v[80:81], v[70:71], v[70:71] op_sel:[0,0] op_sel_hi:[0,1]
    v_pk_fma_f32 v[80:81], v[70:71], v[70:71], v[80:81] op_sel:[1,1,0] op_sel_hi:[1,0,1] neg_lo:[1,0,0]
    v_pk_mul_f32 v[118:119], v[114:115], v[94:95] op_sel:[0,0] op_sel_hi:[0,1]
    v_pk_fma_f32 v[118:119], v[114:115], v[94:95], v[118:119] op_sel:[1,1,0] op_sel_hi:[1,0,1] neg_lo:[1,0,0]
    v_cvt_pk_bf16_f32 v155, v80, v81
    v_cvt_pk_bf16_f32 v156, v118, -v119
    s_mov_b32 m0, s67
    s_nop 0
    ds_write_addtid_b32 v142 offset:25024
    ds_write_addtid_b32 v143 offset:18496
    ds_write_addtid_b32 v144 offset:3264
    ds_write_addtid_b32 v145 offset:25568
    ds_write_addtid_b32 v146 offset:19584
    ds_write_addtid_b32 v147 offset:3808
    ds_write_addtid_b32 v148 offset:26112
    ds_write_addtid_b32 v149 offset:20672
    ds_write_addtid_b32 v150 offset:4352
    ds_write_addtid_b32 v151 offset:26656
    ds_write_addtid_b32 v152 offset:21760
    ds_write_addtid_b32 v153 offset:4896
    ds_write_addtid_b32 v154 offset:27200
    ds_write_addtid_b32 v155 offset:5440
    ds_write_addtid_b32 v156 offset:27744
    v_pk_mul_f32 v[82:83], v[70:71], v[72:73] op_sel:[0,0] op_sel_hi:[0,1]
    v_pk_fma_f32 v[82:83], v[70:71], v[72:73], v[82:83] op_sel:[1,1,0] op_sel_hi:[1,0,1] neg_lo:[1,0,0]
    v_pk_mul_f32 v[120:121], v[116:117], v[94:95] op_sel:[0,0] op_sel_hi:[0,1]
    v_pk_fma_f32 v[120:121], v[116:117], v[94:95], v[120:121] op_sel:[1,1,0] op_sel_hi:[1,0,1] neg_lo:[1,0,0]
    v_cvt_pk_bf16_f32 v157, v82, v83
    v_cvt_pk_bf16_f32 v158, v120, -v121
    v_pk_mul_f32 v[84:85], v[72:73], v[72:73] op_sel:[0,0] op_sel_hi:[0,1]
    v_pk_fma_f32 v[84:85], v[72:73], v[72:73], v[84:85] op_sel:[1,1,0] op_sel_hi:[1,0,1] neg_lo:[1,0,0]
    v_pk_mul_f32 v[114:115], v[118:119], v[94:95] op_sel:[0,0] op_sel_hi:[0,1]
    v_pk_fma_f32 v[114:115], v[118:119], v[94:95], v[114:115] op_sel:[1,1,0] op_sel_hi:[1,0,1] neg_lo:[1,0,0]
    v_cvt_pk_bf16_f32 v159, v84, v85
    v_cvt_pk_bf16_f32 v160, v114, -v115
    v_pk_mul_f32 v[86:87], v[72:73], v[74:75] op_sel:[0,0] op_sel_hi:[0,1]
    v_pk_fma_f32 v[86:87], v[72:73], v[74:75], v[86:87] op_sel:[1,1,0] op_sel_hi:[1,0,1] neg_lo:[1,0,0]
    v_pk_mul_f32 v[116:117], v[120:121], v[94:95] op_sel:[0,0] op_sel_hi:[0,1]
    v_pk_fma_f32 v[116:117], v[120:121], v[94:95], v[116:117] op_sel:[1,1,0] op_sel_hi:[1,0,1] neg_lo:[1,0,0]
    v_cvt_pk_bf16_f32 v161, v86, v87
    v_cvt_pk_bf16_f32 v162, v116, -v117
    v_pk_mul_f32 v[88:89], v[74:75], v[74:75] op_sel:[0,0] op_sel_hi:[0,1]
    v_pk_fma_f32 v[88:89], v[74:75], v[74:75], v[88:89] op_sel:[1,1,0] op_sel_hi:[1,0,1] neg_lo:[1,0,0]
    v_pk_mul_f32 v[118:119], v[114:115], v[94:95] op_sel:[0,0] op_sel_hi:[0,1]
    v_pk_fma_f32 v[118:119], v[114:115], v[94:95], v[118:119] op_sel:[1,1,0] op_sel_hi:[1,0,1] neg_lo:[1,0,0]
    v_cvt_pk_bf16_f32 v163, v88, v89
    v_cvt_pk_bf16_f32 v164, v118, -v119
    v_pk_mul_f32 v[90:91], v[74:75], v[76:77] op_sel:[0,0] op_sel_hi:[0,1]
    v_pk_fma_f32 v[90:91], v[74:75], v[76:77], v[90:91] op_sel:[1,1,0] op_sel_hi:[1,0,1] neg_lo:[1,0,0]
    v_pk_mul_f32 v[120:121], v[116:117], v[94:95] op_sel:[0,0] op_sel_hi:[0,1]
    v_pk_fma_f32 v[120:121], v[116:117], v[94:95], v[120:121] op_sel:[1,1,0] op_sel_hi:[1,0,1] neg_lo:[1,0,0]
    v_cvt_pk_bf16_f32 v165, v90, v91
    v_cvt_pk_bf16_f32 v166, v120, -v121
    v_pk_mul_f32 v[114:115], v[98:99], v[64:65] op_sel:[0,0] op_sel_hi:[0,1]
    v_pk_fma_f32 v[114:115], v[98:99], v[64:65], v[114:115] op_sel:[1,1,0] op_sel_hi:[1,0,1] neg_lo:[1,0,0]
    v_cvt_pk_bf16_f32 v167, v114, v115
    v_pk_mul_f32 v[116:117], v[98:99], v[68:69] op_sel:[0,0] op_sel_hi:[0,1]
    v_pk_fma_f32 v[116:117], v[98:99], v[68:69], v[116:117] op_sel:[1,1,0] op_sel_hi:[1,0,1] neg_lo:[1,0,0]
    v_cvt_pk_bf16_f32 v168, v116, v117
    v_pk_mul_f32 v[118:119], v[98:99], v[72:73] op_sel:[0,0] op_sel_hi:[0,1]
    v_pk_fma_f32 v[118:119], v[98:99], v[72:73], v[118:119] op_sel:[1,1,0] op_sel_hi:[1,0,1] neg_lo:[1,0,0]
    v_cvt_pk_bf16_f32 v169, v118, v119
    v_pk_mul_f32 v[120:121], v[98:99], v[76:77] op_sel:[0,0] op_sel_hi:[0,1]
    v_pk_fma_f32 v[120:121], v[98:99], v[76:77], v[120:121] op_sel:[1,1,0] op_sel_hi:[1,0,1] neg_lo:[1,0,0]
    v_cvt_pk_bf16_f32 v170, v120, v121
    v_pk_mul_f32 v[114:115], v[98:99], v[80:81] op_sel:[0,0] op_sel_hi:[0,1]
    v_pk_fma_f32 v[114:115], v[98:99], v[80:81], v[114:115] op_sel:[1,1,0] op_sel_hi:[1,0,1] neg_lo:[1,0,0]
    v_cvt_pk_bf16_f32 v171, v114, v115
    s_mov_b32 m0, s67
    s_nop 0
    ds_write_addtid_b32 v157 offset:5984
    ds_write_addtid_b32 v158 offset:28288
    ds_write_addtid_b32 v159 offset:6528
    ds_write_addtid_b32 v160 offset:28832
    ds_write_addtid_b32 v161 offset:7072
    ds_write_addtid_b32 v162 offset:29376
    ds_write_addtid_b32 v163 offset:7616
    ds_write_addtid_b32 v164 offset:29920
    ds_write_addtid_b32 v165 offset:8160
    ds_write_addtid_b32 v166 offset:30464
    ds_write_addtid_b32 v167 offset:9248
    ds_write_addtid_b32 v168 offset:9792
    ds_write_addtid_b32 v169 offset:10336
    ds_write_addtid_b32 v170 offset:10880
    ds_write_addtid_b32 v171 offset:11424
    v_pk_mul_f32 v[116:117], v[98:99], v[84:85] op_sel:[0,0] op_sel_hi:[0,1]
    v_pk_fma_f32 v[116:117], v[98:99], v[84:85], v[116:117] op_sel:[1,1,0] op_sel_hi:[1,0,1] neg_lo:[1,0,0]
    v_cvt_pk_bf16_f32 v172, v116, v117
    v_pk_mul_f32 v[118:119], v[98:99], v[88:89] op_sel:[0,0] op_sel_hi:[0,1]
    v_pk_fma_f32 v[118:119], v[98:99], v[88:89], v[118:119] op_sel:[1,1,0] op_sel_hi:[1,0,1] neg_lo:[1,0,0]
    v_cvt_pk_bf16_f32 v173, v118, v119
    v_pk_mul_f32 v[120:121], v[100:101], v[68:69] op_sel:[0,0] op_sel_hi:[0,1]
    v_pk_fma_f32 v[120:121], v[100:101], v[68:69], v[120:121] op_sel:[1,1,0] op_sel_hi:[1,0,1] neg_lo:[1,0,0]
    v_cvt_pk_bf16_f32 v174, v120, v121
    v_pk_mul_f32 v[114:115], v[100:101], v[76:77] op_sel:[0,0] op_sel_hi:[0,1]
    v_pk_fma_f32 v[114:115], v[100:101], v[76:77], v[114:115] op_sel:[1,1,0] op_sel_hi:[1,0,1] neg_lo:[1,0,0]
    v_cvt_pk_bf16_f32 v175, v114, v115
    v_pk_mul_f32 v[116:117], v[100:101], v[84:85] op_sel:[0,0] op_sel_hi:[0,1]
    v_pk_fma_f32 v[116:117], v[100:101], v[84:85], v[116:117] op_sel:[1,1,0] op_sel_hi:[1,0,1] neg_lo:[1,0,0]
    v_cvt_pk_bf16_f32 v176, v116, v117
    v_pk_mul_f32 v[118:119], v[102:103], v[68:69] op_sel:[0,0] op_sel_hi:[0,1]
    v_pk_fma_f32 v[118:119], v[102:103], v[68:69], v[118:119] op_sel:[1,1,0] op_sel_hi:[1,0,1] neg_lo:[1,0,0]
    v_cvt_pk_bf16_f32 v177, v118, v119
    v_pk_mul_f32 v[120:121], v[102:103], v[76:77] op_sel:[0,0] op_sel_hi:[0,1]
    v_pk_fma_f32 v[120:121], v[102:103], v[76:77], v[120:121] op_sel:[1,1,0] op_sel_hi:[1,0,1] neg_lo:[1,0,0]
    v_cvt_pk_bf16_f32 v178, v120, v121
    v_pk_mul_f32 v[114:115], v[102:103], v[84:85] op_sel:[0,0] op_sel_hi:[0,1]
    v_pk_fma_f32 v[114:115], v[102:103], v[84:85], v[114:115] op_sel:[1,1,0] op_sel_hi:[1,0,1] neg_lo:[1,0,0]
    v_cvt_pk_bf16_f32 v179, v114, v115
    v_pk_mul_f32 v[116:117], v[104:105], v[76:77] op_sel:[0,0] op_sel_hi:[0,1]
    v_pk_fma_f32 v[116:117], v[104:105], v[76:77], v[116:117] op_sel:[1,1,0] op_sel_hi:[1,0,1] neg_lo:[1,0,0]
    v_cvt_pk_bf16_f32 v180, v116, v117
    v_pk_mul_f32 v[118:119], v[106:107], v[76:77] op_sel:[0,0] op_sel_hi:[0,1]
    v_pk_fma_f32 v[118:119], v[106:107], v[76:77], v[118:119] op_sel:[1,1,0] op_sel_hi:[1,0,1] neg_lo:[1,0,0]
    v_cvt_pk_bf16_f32 v181, v118, v119
    v_pk_mul_f32 v[120:121], v[108:109], v[76:77] op_sel:[0,0] op_sel_hi:[0,1]
    v_pk_fma_f32 v[120:121], v[108:109], v[76:77], v[120:121] op_sel:[1,1,0] op_sel_hi:[1,0,1] neg_lo:[1,0,0]
    v_cvt_pk_bf16_f32 v182, v120, v121
    v_pk_mul_f32 v[114:115], v[110:111], v[76:77] op_sel:[0,0] op_sel_hi:[0,1]
    v_pk_fma_f32 v[114:115], v[110:111], v[76:77], v[114:115] op_sel:[1,1,0] op_sel_hi:[1,0,1] neg_lo:[1,0,0]
    v_cvt_pk_bf16_f32 v183, v114, v115
    s_mov_b32 m0, s67
    s_nop 0
    ds_write_addtid_b32 v172 offset:11968
    ds_write_addtid_b32 v173 offset:12512
    ds_write_addtid_b32 v174 offset:13600
    ds_write_addtid_b32 v175 offset:14144
    ds_write_addtid_b32 v176 offset:14688
    ds_write_addtid_b32 v177 offset:15776
    ds_write_addtid_b32 v178 offset:16320
    ds_write_addtid_b32 v179 offset:16864
    ds_write_addtid_b32 v180 offset:17952
    ds_write_addtid_b32 v181 offset:19040
    ds_write_addtid_b32 v182 offset:20128
    ds_write_addtid_b32 v183 offset:21216
    s_waitcnt lgkmcnt(0)
    s_barrier
    ds_read_b128 v[60:63], v57 offset:22304
    ds_read_b128 v[92:95], v58 offset:0
    ds_read_b128 v[64:67], v57 offset:22368
    ds_read_b128 v[96:99], v58 offset:64
    ds_read_b128 v[68:71], v57 offset:22432
    ds_read_b128 v[100:103], v58 offset:128
    ds_read_b128 v[72:75], v57 offset:22496
    ds_read_b128 v[104:107], v58 offset:192
    ds_read_b128 v[76:79], v57 offset:22560
    ds_read_b128 v[108:111], v58 offset:256
    ds_read_b128 v[80:83], v57 offset:22624
    ds_read_b128 v[112:115], v58 offset:320
    ds_read_b128 v[84:87], v57 offset:22688
    ds_read_b128 v[116:119], v58 offset:384
    ds_read_b128 v[88:91], v57 offset:22752
    ds_read_b128 v[120:123], v58 offset:448
    s_waitcnt lgkmcnt(14)
    v_mfma_f32_16x16x32_bf16 v[16:19], v[92:95], v[60:63], 0
    ds_read_b128 v[124:127], v57 offset:17408
    s_add_u32 m0, s60, 12288
    s_add_u32 s15, s14, 344064
    s_nop 0
    buffer_load_dwordx4 v240, s[52:55], s15 offen offset:0  lds
    s_waitcnt lgkmcnt(13)
    v_mfma_f32_16x16x32_bf16 v[16:19], v[96:99], v[64:67], v[16:19]
    ds_read_b128 v[128:131], v57 offset:17472
    buffer_load_dwordx4 v241, s[52:55], s15 offen offset:1024  lds
    s_waitcnt lgkmcnt(12)
    v_mfma_f32_16x16x32_bf16 v[16:19], v[100:103], v[68:71], v[16:19]
    ds_read_b128 v[132:135], v57 offset:17536
    buffer_load_dwordx4 v242, s[52:55], s15 offen offset:2048  lds
    s_waitcnt lgkmcnt(11)
    v_mfma_f32_16x16x32_bf16 v[16:19], v[104:107], v[72:75], v[16:19]
    ds_read_b128 v[136:139], v57 offset:17600
    buffer_load_dwordx4 v243, s[52:55], s15 offen offset:3072  lds
    s_waitcnt lgkmcnt(10)
    v_mfma_f32_16x16x32_bf16 v[16:19], v[108:111], v[76:79], v[16:19]
    ds_read_b128 v[140:143], v57 offset:17664
    s_waitcnt lgkmcnt(9)
    v_mfma_f32_16x16x32_bf16 v[16:19], v[112:115], v[80:83], v[16:19]
    s_nop 0
    ds_read_b128 v[144:147], v57 offset:17728
    s_waitcnt lgkmcnt(8)
    v_mfma_f32_16x16x32_bf16 v[16:19], v[116:119], v[84:87], v[16:19]
    ds_read_b128 v[148:151], v57 offset:17792
    s_waitcnt lgkmcnt(7)
    v_mfma_f32_16x16x32_bf16 v[16:19], v[120:123], v[88:91], v[16:19]
    ds_read_b128 v[152:155], v57 offset:17856
    s_waitcnt vmcnt(14)
    s_waitcnt lgkmcnt(7)
    v_mfma_f32_16x16x32_bf16 v[20:23], v[124:127], v[60:63], 0
    ds_read_b64_tr_b16 a[0:1], v244 offset:0
    global_load_dwordx4 v[176:179], v194, s[44:45] offset:-4096 sc1
    s_waitcnt lgkmcnt(7)
    v_mfma_f32_16x16x32_bf16 v[20:23], v[128:131], v[64:67], v[20:23]
    ds_read_b64_tr_b16 a[2:3], v244 offset:1024
    s_waitcnt lgkmcnt(7)
    v_mfma_f32_16x16x32_bf16 v[20:23], v[132:135], v[68:71], v[20:23]
    ds_read_b64_tr_b16 a[128:129], v245 offset:0
    global_load_dwordx4 v[180:183], v194, s[44:45] offset:0 sc1
    s_waitcnt lgkmcnt(7)
    v_mfma_f32_16x16x32_bf16 v[20:23], v[136:139], v[72:75], v[20:23]
    ds_read_b64_tr_b16 a[130:131], v245 offset:1024
    s_waitcnt lgkmcnt(7)
    v_mfma_f32_16x16x32_bf16 v[20:23], v[140:143], v[76:79], v[20:23]
    ds_read_b64_tr_b16 a[4:5], v244 offset:2048
    global_load_dwordx4 v[184:187], v195, s[44:45] offset:-4096 sc1
    s_waitcnt lgkmcnt(7)
    v_mfma_f32_16x16x32_bf16 v[20:23], v[144:147], v[80:83], v[20:23]
    s_nop 0
    ds_read_b64_tr_b16 a[6:7], v244 offset:3072
    s_waitcnt lgkmcnt(7)
    v_mfma_f32_16x16x32_bf16 v[20:23], v[148:151], v[84:87], v[20:23]
    ds_read_b64_tr_b16 a[132:133], v245 offset:2048
    global_load_dwordx4 v[188:191], v195, s[44:45] offset:0 sc1
    s_waitcnt lgkmcnt(7)
    v_mfma_f32_16x16x32_bf16 v[20:23], v[152:155], v[88:91], v[20:23]
    ds_read_b64_tr_b16 a[134:135], v245 offset:3072
    v_cvt_pk_bf16_f32 v16, v16, v17
    v_cvt_pk_bf16_f32 v17, v18, v19
    ds_write_b16 v52, v16
    ds_write_b16_d16_hi v53, v16
    ds_write_b16 v54, v17
    ds_write_b16_d16_hi v55, v17
    global_load_dwordx4 v[160:163], v192, s[44:45] offset:-4096 sc1
    v_cvt_pk_bf16_f32 v20, v20, v21
    v_cvt_pk_bf16_f32 v21, v22, v23
    ds_write_b16 v56, v20 offset:2048
    ds_write_b16_d16_hi v56, v20 offset:2064
    ds_write_b16 v56, v21 offset:2560
    ds_write_b16_d16_hi v56, v21 offset:2576
    global_load_dwordx4 v[164:167], v192, s[44:45] offset:0 sc1
    s_lshl_b32 s64, s46, 8
    s_add_u32 m0, s64, 32
    v_mov_b32 v8, 0
    v_mov_b32 v9, 0
    v_mov_b32 v10, 0
    v_mov_b32 v11, 0
    s_waitcnt lgkmcnt(0)
    s_barrier
    ds_read_u16 v60, v40 offset:0
    ds_read_u16 v61, v41 offset:0
    ds_read_u16 v62, v42 offset:0
    ds_read_u16 v63, v43 offset:0
    ds_read_u16 v64, v44 offset:0
    ds_read_u16 v65, v45 offset:0
    ds_read_u16 v66, v46 offset:0
    ds_read_u16 v67, v47 offset:0
    ds_read_u16 v68, v48 offset:0
    ds_read_u16 v69, v49 offset:0
    ds_read_u16 v70, v50 offset:0
    ds_read_u16 v71, v51 offset:0
    global_load_dwordx4 v[168:171], v193, s[44:45] offset:-4096 sc1
    ds_read_u16 v72, v40 offset:6208
    ds_read_u16 v73, v41 offset:6208
    ds_read_u16 v74, v42 offset:6208
    ds_read_u16 v75, v43 offset:6208
    ds_read_u16 v76, v44 offset:6208
    ds_read_u16 v77, v45 offset:6208
    ds_read_u16 v78, v46 offset:6208
    ds_read_u16 v79, v47 offset:6208
    ds_read_u16 v80, v48 offset:6208
    ds_read_u16 v81, v49 offset:6208
    ds_read_u16 v82, v50 offset:6208
    ds_read_u16 v83, v51 offset:6208
    global_load_dwordx4 v[172:175], v193, s[44:45] offset:0 sc1
    ds_write_b128 v59, v[8:11]
    ds_read_b64_tr_b16 a[8:9], v244 offset:4096
    ds_read_b64_tr_b16 a[10:11], v244 offset:5120
    ds_read_b64_tr_b16 a[136:137], v245 offset:4096
    ds_read_b64_tr_b16 a[138:139], v245 offset:5120
    ds_read_b64_tr_b16 a[12:13], v244 offset:6144
    ds_read_b64_tr_b16 a[14:15], v244 offset:7168
    ds_read_b64_tr_b16 a[140:141], v245 offset:6144
    ds_read_b64_tr_b16 a[142:143], v245 offset:7168
    s_waitcnt lgkmcnt(14)
    v_lshl_or_b32 v60, v61, 16, v60
    v_lshl_or_b32 v61, v62, 16, v61
    v_lshl_or_b32 v63, v64, 16, v63
    s_nop 0
    v_lshl_or_b32 v64, v65, 16, v64
    v_lshl_or_b32 v66, v67, 16, v66
    v_lshl_or_b32 v67, v68, 16, v67
    v_lshl_or_b32 v69, v70, 16, v69
    v_lshl_or_b32 v70, v71, 16, v70
    ds_write_addtid_b32 v60 offset:0
    ds_write_addtid_b32 v61 offset:4384
    ds_write_addtid_b32 v60 offset:8764
    ds_write_addtid_b32 v61 offset:13148
    ds_write_addtid_b32 v63 offset:1024
    ds_write_addtid_b32 v64 offset:5408
    ds_write_addtid_b32 v63 offset:9788
    ds_write_addtid_b32 v64 offset:14172
    s_waitcnt lgkmcnt(8)
    s_add_u32 m0, s60, 0
    s_add_u32 s15, s14, 458752
    buffer_load_dwordx4 v240, s[52:55], s15 offen offset:0  lds
    s_add_u32 m0, s64, 32
    s_nop 0
    ds_write_addtid_b32 v66 offset:2048
    ds_write_addtid_b32 v67 offset:6432
    ds_write_addtid_b32 v66 offset:10812
    ds_write_addtid_b32 v67 offset:15196
    ds_write_addtid_b32 v69 offset:3072
    ds_write_addtid_b32 v70 offset:7456
    ds_write_addtid_b32 v69 offset:11836
    ds_write_addtid_b32 v70 offset:16220
    s_add_u32 m0, s60, 0
    s_add_u32 s15, s14, 458752
    buffer_load_dwordx4 v241, s[52:55], s15 offen offset:1024  lds
    s_add_u32 m0, s64, 32
    s_nop 0
    v_lshl_or_b32 v72, v73, 16, v72
    v_lshl_or_b32 v73, v74, 16, v73
    v_lshl_or_b32 v75, v76, 16, v75
    s_nop 0
    v_lshl_or_b32 v76, v77, 16, v76
    v_lshl_or_b32 v78, v79, 16, v78
    v_lshl_or_b32 v79, v80, 16, v79
    v_lshl_or_b32 v81, v82, 16, v81
    v_lshl_or_b32 v82, v83, 16, v82
    ds_write_addtid_b32 v72 offset:17536
    ds_write_addtid_b32 v73 offset:21920
    ds_write_addtid_b32 v72 offset:26300
    ds_write_addtid_b32 v73 offset:30684
    ds_write_addtid_b32 v75 offset:18560
    ds_write_addtid_b32 v76 offset:22944
    ds_write_addtid_b32 v75 offset:27324
    ds_write_addtid_b32 v76 offset:31708
    s_add_u32 m0, s60, 0
    s_add_u32 s15, s14, 458752
    buffer_load_dwordx4 v242, s[52:55], s15 offen offset:2048  lds
    s_add_u32 m0, s64, 32
    s_nop 0
    ds_write_addtid_b32 v78 offset:19584
    ds_write_addtid_b32 v79 offset:23968
    ds_write_addtid_b32 v78 offset:28348
    ds_write_addtid_b32 v79 offset:32732
    ds_write_addtid_b32 v81 offset:20608
    ds_write_addtid_b32 v82 offset:24992
    ds_write_addtid_b32 v81 offset:29372
    s_nop 0
    ds_write_addtid_b32 v82 offset:33756
    s_add_u32 m0, s60, 0
    s_add_u32 s15, s14, 458752
    buffer_load_dwordx4 v243, s[52:55], s15 offen offset:3072  lds
    s_add_u32 m0, s64, 32
    s_nop 0
    s_mov_b64 exec, 15
    ds_write_b32 v231, v8
    s_mov_b64 exec, -1
    s_waitcnt vmcnt(12)
    ds_read_b64_tr_b16 a[16:17], v244 offset:8192
    ds_read_b64_tr_b16 a[18:19], v244 offset:9216
    ds_read_b64_tr_b16 a[144:145], v245 offset:8192
    ds_read_b64_tr_b16 a[146:147], v245 offset:9216
    ds_read_b64_tr_b16 a[20:21], v244 offset:10240
    ds_read_b64_tr_b16 a[22:23], v244 offset:11264
    ds_read_b64_tr_b16 a[148:149], v245 offset:10240
    ds_read_b64_tr_b16 a[150:151], v245 offset:11264
    ds_read_b64_tr_b16 a[24:25], v244 offset:12288
    ds_read_b64_tr_b16 a[26:27], v244 offset:13312
    ds_read_b64_tr_b16 a[152:153], v245 offset:12288
    ds_read_b64_tr_b16 a[154:155], v245 offset:13312
    ds_read_b64_tr_b16 a[28:29], v244 offset:14336
    ds_read_b64_tr_b16 a[30:31], v244 offset:15360
    ds_read_b64_tr_b16 a[156:157], v245 offset:14336
    ds_read_b64_tr_b16 a[158:159], v245 offset:15360
    s_add_u32 m0, s60, 4096
    s_add_u32 s15, s14, 573440
    buffer_load_dwordx4 v240, s[52:55], s15 offen offset:0  lds
    s_add_u32 m0, s60, 4096
    s_add_u32 s15, s14, 573440
    buffer_load_dwordx4 v241, s[52:55], s15 offen offset:1024  lds
    s_add_u32 m0, s60, 4096
    s_add_u32 s15, s14, 573440
    buffer_load_dwordx4 v242, s[52:55], s15 offen offset:2048  lds
    v_mov_b32_e64 v1, s4
    s_lshl_b32 s64, s46, 8
    s_add_u32 s66, s64, 35104
    s_lshl_b32 s65, s9, 9
    s_add_u32 s64, s64, s65
    s_add_u32 s64, s64, 43808
    s_waitcnt vmcnt(7)
L_p1chk_1:
    v_bitop3_b32 v2, v163, v179, v1 bitop3:0x7e
    v_bitop3_b32 v3, v167, v183, v1 bitop3:0x7e
    v_bitop3_b32 v4, v171, v187, v1 bitop3:0x7e
    v_bitop3_b32 v5, v175, v191, v1 bitop3:0x7e
    v_or3_b32 v2, v2, v3, v4
    v_or_b32 v2, v2, v5
    v_cmp_ne_u32 vcc, 0, v2
    s_cbranch_vccz L_p1chk_1_go
    s_add_u32 s8, s8, 1
    s_cmp_ge_u32 s8, 262144
    s_cbranch_scc1 L_p1chk_1_go
    s_mov_b64 exec, vcc
    global_load_dwordx4 v[160:163], v192, s[44:45] offset:-4096 sc1
    global_load_dwordx4 v[164:167], v192, s[44:45] offset:0 sc1
    global_load_dwordx4 v[168:171], v193, s[44:45] offset:-4096 sc1
    global_load_dwordx4 v[172:175], v193, s[44:45] offset:0 sc1
    global_load_dwordx4 v[176:179], v194, s[44:45] offset:-4096 sc1
    global_load_dwordx4 v[180:183], v194, s[44:45] offset:0 sc1
    global_load_dwordx4 v[184:187], v195, s[44:45] offset:-4096 sc1
    global_load_dwordx4 v[188:191], v195, s[44:45] offset:0 sc1
    s_mov_b64 exec, -1
    s_waitcnt vmcnt(0)
    s_branch L_p1chk_1
L_p1chk_1_go:
    v_mov_b32 v230, s101
    v_bitop3_b32 v229, v162, v166, v230 bitop3:0x7e
    v_bitop3_b32 v230, v170, v174, v230 bitop3:0x7e
    v_and_b32 v179, 0xffff0000, v178
    v_lshlrev_b32 v178, 16, v178
    v_lshlrev_b32 v88, 16, v160
    v_and_b32 v89, 0xffff0000, v160
    v_pk_fma_f32 v[104:105], v[88:89], v[176:177], v[178:179] op_sel:[0,0,0] op_sel_hi:[1,0,0]
    v_lshlrev_b32_e64 v90, 16, v161
    v_and_b32 v91, 0xffff0000, v161
    v_pk_fma_f32 v[106:107], v[90:91], v[176:177], v[178:179] op_sel:[0,1,1] op_sel_hi:[1,1,1]
    s_add_u32 m0, s60, 4096
    s_add_u32 s15, s14, 573440
    buffer_load_dwordx4 v243, s[52:55], s15 offen offset:3072  lds
    v_cvt_pk_bf16_f32 v120, v104, v106
    v_cvt_pk_bf16_f32 v124, v105, v107
    v_and_b32 v183, 0xffff0000, v182
    v_lshlrev_b32 v182, 16, v182
    v_lshlrev_b32 v92, 16, v164
    v_and_b32 v93, 0xffff0000, v164
    v_pk_fma_f32 v[108:109], v[92:93], v[180:181], v[182:183] op_sel:[0,0,0] op_sel_hi:[1,0,0]
    v_lshlrev_b32 v94, 16, v165
    v_and_b32 v95, 0xffff0000, v165
    v_pk_fma_f32 v[110:111], v[94:95], v[180:181], v[182:183] op_sel:[0,1,1] op_sel_hi:[1,1,1]
    s_waitcnt lgkmcnt(0)
    s_add_u32 m0, s60, 8192
    s_add_u32 s15, s14, 688128
    buffer_load_dwordx4 v240, s[52:55], s15 offen offset:0  lds
    v_cvt_pk_bf16_f32 v121, v108, v110
    v_cvt_pk_bf16_f32 v125, v109, v111
    v_and_b32 v187, 0xffff0000, v186
    v_lshlrev_b32 v186, 16, v186
    v_lshlrev_b32 v96, 16, v168
    v_and_b32 v97, 0xffff0000, v168
    v_pk_fma_f32 v[112:113], v[96:97], v[184:185], v[186:187] op_sel:[0,0,0] op_sel_hi:[1,0,0]
    v_lshlrev_b32_e64 v98, 16, v169
    v_and_b32 v99, 0xffff0000, v169
    v_pk_fma_f32 v[114:115], v[98:99], v[184:185], v[186:187] op_sel:[0,1,1] op_sel_hi:[1,1,1]
    s_add_u32 m0, s60, 8192
    s_add_u32 s15, s14, 688128
    buffer_load_dwordx4 v241, s[52:55], s15 offen offset:1024  lds
    v_cvt_pk_bf16_f32 v122, v112, v114
    v_cvt_pk_bf16_f32 v126, v113, v115
    v_and_b32 v191, 0xffff0000, v190
    v_lshlrev_b32 v190, 16, v190
    v_lshlrev_b32 v100, 16, v172
    v_and_b32 v101, 0xffff0000, v172
    v_pk_fma_f32 v[116:117], v[100:101], v[188:189], v[190:191] op_sel:[0,0,0] op_sel_hi:[1,0,0]
    v_lshlrev_b32 v102, 16, v173
    v_and_b32 v103, 0xffff0000, v173
    v_pk_fma_f32 v[118:119], v[102:103], v[188:189], v[190:191] op_sel:[0,1,1] op_sel_hi:[1,1,1]
    s_add_u32 m0, s60, 8192
    s_add_u32 s15, s14, 688128
    buffer_load_dwordx4 v242, s[52:55], s15 offen offset:2048  lds
    s_mov_b32 m0, s66
    v_cvt_pk_bf16_f32 v123, v116, v118
    v_cvt_pk_bf16_f32 v127, v117, v119
    ds_write_addtid_b32 v120 offset:256
    ds_write_addtid_b32 v124 offset:4608
    ds_write_addtid_b32 v121 offset:1280
    ds_write_addtid_b32 v125 offset:5632
    ds_write_addtid_b32 v122 offset:2304
    ds_write_addtid_b32 v126 offset:6656
    ds_write_addtid_b32 v123 offset:3328
    ds_write_addtid_b32 v127 offset:7680
    s_add_u32 m0, s60, 8192
    s_add_u32 s15, s14, 688128
    buffer_load_dwordx4 v243, s[52:55], s15 offen offset:3072  lds
    s_mov_b32 m0, s64
    v_pk_fma_f32 v[88:89], v[104:105], s[68:69], v[88:89]
    v_pk_fma_f32 v[90:91], v[106:107], s[68:69], v[90:91]
    s_nop 0
    v_pk_fma_f32 v[92:93], v[108:109], s[68:69], v[92:93]
    v_pk_fma_f32 v[94:95], v[110:111], s[68:69], v[94:95]
    v_pk_fma_f32 v[96:97], v[112:113], s[68:69], v[96:97]
    v_pk_fma_f32 v[98:99], v[114:115], s[68:69], v[98:99]
    v_pk_fma_f32 v[100:101], v[116:117], s[68:69], v[100:101]
    v_pk_fma_f32 v[102:103], v[118:119], s[68:69], v[102:103]
    ds_write_addtid_b32 v88 offset:0
    ds_write_addtid_b32 v89 offset:8192
    ds_write_addtid_b32 v90 offset:512
    ds_write_addtid_b32 v91 offset:8704
    ds_write_addtid_b32 v92 offset:2048
    ds_write_addtid_b32 v93 offset:10240
    ds_write_addtid_b32 v94 offset:2560
    ds_write_addtid_b32 v95 offset:10752
    ds_write_addtid_b32 v96 offset:4096
    ds_write_addtid_b32 v97 offset:12288
    ds_write_addtid_b32 v98 offset:4608
    ds_write_addtid_b32 v99 offset:12800
    ds_write_addtid_b32 v100 offset:6144
    ds_write_addtid_b32 v101 offset:14336
    ds_write_addtid_b32 v102 offset:6656
    ds_write_addtid_b32 v103 offset:14848
    s_add_u32 m0, s60, 12288
    s_add_u32 s15, s14, 802816
    buffer_load_dwordx4 v240, s[52:55], s15 offen offset:0  lds
    s_waitcnt lgkmcnt(0)
    s_barrier
    ds_read_b128 v[92:95], v197 offset:448
    ds_read_b64 v[60:61], v196 offset:3776
    ds_read_b64 v[62:63], v196 offset:3784
    ds_read_b128 v[96:99], v197 offset:960
    ds_read_b64 v[64:65], v196 offset:3264
    ds_read_b64 v[66:67], v196 offset:3272
    ds_read_b128 v[100:103], v197 offset:1472
    ds_read_b64 v[68:69], v196 offset:2752
    ds_read_b64 v[70:71], v196 offset:2760
    ds_read_b128 v[104:107], v197 offset:1984
    ds_read_b64 v[72:73], v196 offset:2240
    ds_read_b64 v[74:75], v196 offset:2248
    s_cmp_eq_u32 s7, 0
    s_cbranch_scc1 L_epoch_3
L_noepoch_4:
    s_waitcnt lgkmcnt(9)
    s_nop 0
    v_mfma_f32_16x16x32_bf16 v[12:15], v[60:63], v[92:95], 0
    ds_read_b128 v[108:111], v197 offset:2496
    v_or_b32 v229, v229, v230
    s_waitcnt lgkmcnt(7)
    v_mfma_f32_16x16x32_bf16 v[16:19], v[60:63], v[96:99], 0
    s_add_u32 m0, s60, 12288
    s_add_u32 s15, s14, 802816
    buffer_load_dwordx4 v241, s[52:55], s15 offen offset:1024  lds
    v_bfe_u32 v230, v0, 2, 3
    v_mfma_f32_16x16x32_bf16 v[16:19], v[64:67], v[92:95], v[16:19]
    ds_read_b64 v[76:77], v196 offset:1728
    v_cmp_eq_u32 vcc, s47, v230
    v_mfma_f32_16x16x32_bf16 v[20:23], v[64:67], v[96:99], 0
    ds_read_b64 v[78:79], v196 offset:1736
    s_nop 0
    v_lshrrev_b32 v230, 6, v0
    s_waitcnt lgkmcnt(6)
    v_mfma_f32_16x16x32_bf16 v[20:23], v[60:63], v[100:103], v[20:23]
    s_add_u32 m0, s60, 12288
    s_add_u32 s15, s14, 802816
    buffer_load_dwordx4 v242, s[52:55], s15 offen offset:2048  lds
    v_cndmask_b32 v229, 0, v229, vcc
    v_mfma_f32_16x16x32_bf16 v[24:27], v[64:67], v[100:103], 0
    ds_read_b128 v[112:115], v197 offset:3008
    v_lshlrev_b32 v230, 2, v230
    v_mfma_f32_16x16x32_bf16 v[20:23], v[68:71], v[92:95], v[20:23]
    ds_read_b64 v[80:81], v196 offset:1216
    v_cmp_ne_u32_e64 vcc, 0, v229
    v_mfma_f32_16x16x32_bf16 v[24:27], v[68:71], v[96:99], v[24:27]
    s_add_u32 m0, s60, 12288
    s_add_u32 s15, s14, 802816
    buffer_load_dwordx4 v243, s[52:55], s15 offen offset:3072  lds
    s_nop 0
    s_or_b32 s64, vcc_lo, vcc_hi
    v_mfma_f32_16x16x32_bf16 v[28:31], v[68:71], v[100:103], 0
    ds_read_b64 v[82:83], v196 offset:1224
    v_mov_b32 v229, s64
    s_waitcnt lgkmcnt(6)
    v_mfma_f32_16x16x32_bf16 v[24:27], v[60:63], v[104:107], v[24:27]
    ds_write_b32 v230, v229 offset:60192
    v_mov_b32 v224, s4
    v_mfma_f32_16x16x32_bf16 v[28:31], v[64:67], v[104:107], v[28:31]
    global_store_dwordx4 v228, v[232:235], s[44:45] sc1
    v_mov_b32 v225, s4
    v_mfma_f32_16x16x32_bf16 v[32:35], v[68:71], v[104:107], 0
    ds_read_b128 v[116:119], v197 offset:3520
    v_mov_b32_e64 v226, s4
    v_mfma_f32_16x16x32_bf16 v[24:27], v[72:75], v[92:95], v[24:27]
    ds_read_b64 v[84:85], v196 offset:704
    v_mov_b32 v227, s4
    v_mfma_f32_16x16x32_bf16 v[28:31], v[72:75], v[96:99], v[28:31]
    global_store_dwordx4 v228, v[232:235], s[44:45] offset:2048 sc1
    s_nop 0
    s_lshl_b32 s64, s2, 6
    s_add_u32 s64, s64, 65536
    v_add_u32 v220, s64, v252
    v_mfma_f32_16x16x32_bf16 v[32:35], v[72:75], v[100:103], v[32:35]
    ds_read_b64 v[86:87], v196 offset:712
    ds_read_b64 v[44:45], v198 offset:0
    v_mfma_f32_16x16x32_bf16 v[36:39], v[72:75], v[104:107], 0
    ds_read_b128 v[120:123], v197 offset:4032
    s_waitcnt lgkmcnt(9)
    v_mfma_f32_16x16x32_bf16 v[28:31], v[60:63], v[108:111], v[28:31]
    s_add_u32 m0, s61, 0
    s_add_u32 s15, s14, 917504
    buffer_load_dwordx4 v240, s[52:55], s15 offen offset:0  lds
    ds_read_b64 v[46:47], v198 offset:512
    v_mfma_f32_16x16x32_bf16 v[32:35], v[64:67], v[108:111], v[32:35]
    ds_read_b64 v[88:89], v196 offset:192
    v_mfma_f32_16x16x32_bf16 v[36:39], v[68:71], v[108:111], v[36:39]
    ds_read_b64 v[90:91], v196 offset:200
    ds_read_b64 v[48:49], v198 offset:2048
    v_mfma_f32_16x16x32_bf16 v[40:43], v[72:75], v[108:111], 0
    buffer_load_dwordx4 v241, s[52:55], s15 offen offset:1024  lds
    v_mfma_f32_16x16x32_bf16 v[28:31], v[76:79], v[92:95], v[28:31]
    ds_read_b128 v[156:159], v197 offset:384
    ds_read_b64 v[50:51], v198 offset:2560
    v_mfma_f32_16x16x32_bf16 v[32:35], v[76:79], v[96:99], v[32:35]
    ds_read_b64 v[124:125], v196 offset:3712
    v_mfma_f32_16x16x32_bf16 v[36:39], v[76:79], v[100:103], v[36:39]
    buffer_load_dwordx4 v242, s[52:55], s15 offen offset:2048  lds
    ds_read_b64 v[52:53], v198 offset:4096
    v_mfma_f32_16x16x32_bf16 v[40:43], v[76:79], v[104:107], v[40:43]
    ds_read_b64 v[126:127], v196 offset:3720
    s_waitcnt lgkmcnt(14)
    v_mfma_f32_16x16x32_bf16 v[32:35], v[60:63], v[112:115], v[32:35]
    ds_read_b128 v[160:163], v197 offset:896
    ds_read_b64 v[54:55], v198 offset:4608
    v_mfma_f32_16x16x32_bf16 v[36:39], v[64:67], v[112:115], v[36:39]
    buffer_load_dwordx4 v243, s[52:55], s15 offen offset:3072  lds
    s_nop 0
    v_mfma_f32_16x16x32_bf16 v[40:43], v[68:71], v[112:115], v[40:43]
    ds_read_b64 v[128:129], v196 offset:3200
    ds_read_b64 v[56:57], v198 offset:6144
    v_mfma_f32_16x16x32_bf16 v[32:35], v[80:83], v[92:95], v[32:35]
    ds_read_b64 v[130:131], v196 offset:3208
    v_mfma_f32_16x16x32_bf16 v[36:39], v[80:83], v[96:99], v[36:39]
    s_add_u32 m0, s61, 4096
    s_add_u32 s15, s14, 1032192
    buffer_load_dwordx4 v240, s[52:55], s15 offen offset:0  lds
    ds_read_b64 v[58:59], v198 offset:6656
    v_mfma_f32_16x16x32_bf16 v[40:43], v[80:83], v[100:103], v[40:43]
    ds_read_b128 v[164:167], v197 offset:1408
    s_waitcnt lgkmcnt(14)
    v_mfma_f32_16x16x32_bf16 v[36:39], v[60:63], v[116:119], v[36:39]
    ds_read_b64 v[132:133], v196 offset:2688
    s_waitcnt vmcnt(15)
    ds_read_b64_tr_b16 a[32:33], v244 offset:0
    v_mfma_f32_16x16x32_bf16 v[40:43], v[64:67], v[116:119], v[40:43]
    buffer_load_dwordx4 v241, s[52:55], s15 offen offset:1024  lds
    v_mfma_f32_16x16x32_bf16 v[36:39], v[84:87], v[92:95], v[36:39]
    ds_read_b64 v[134:135], v196 offset:2696
    ds_read_b64_tr_b16 a[34:35], v244 offset:1024
    v_mfma_f32_16x16x32_bf16 v[40:43], v[84:87], v[96:99], v[40:43]
    ds_read_b128 v[168:171], v197 offset:1920
    s_waitcnt lgkmcnt(14)
    s_nop 0
    v_mfma_f32_16x16x32_bf16 v[40:43], v[60:63], v[120:123], v[40:43]
    buffer_load_dwordx4 v242, s[52:55], s15 offen offset:2048  lds
    ds_read_b64_tr_b16 a[160:161], v245 offset:0
    v_mfma_f32_16x16x32_bf16 v[40:43], v[88:91], v[92:95], v[40:43]
    ds_read_b64 v[136:137], v196 offset:2176
    s_waitcnt lgkmcnt(14)
    v_mfma_f32_16x16x32_bf16 v[12:15], v[124:127], v[156:159], v[12:15]
    ds_read_b64 v[138:139], v196 offset:2184
    s_nop 0
    ds_read_b64_tr_b16 a[162:163], v245 offset:1024
    s_waitcnt lgkmcnt(11)
    v_mfma_f32_16x16x32_bf16 v[16:19], v[124:127], v[160:163], v[16:19]
    buffer_load_dwordx4 v243, s[52:55], s15 offen offset:3072  lds
    v_mfma_f32_16x16x32_bf16 v[16:19], v[128:131], v[156:159], v[16:19]
    ds_read_b128 v[172:175], v197 offset:2432
    ds_read_b64_tr_b16 a[36:37], v244 offset:2048
    v_mfma_f32_16x16x32_bf16 v[20:23], v[128:131], v[160:163], v[20:23]
    s_nop 0
    ds_read_b64 v[140:141], v196 offset:1664
    s_waitcnt lgkmcnt(9)
    v_mfma_f32_16x16x32_bf16 v[20:23], v[124:127], v[164:167], v[20:23]
    ds_read_b64 v[142:143], v196 offset:1672
    ds_read_b64_tr_b16 a[38:39], v244 offset:3072
    v_mfma_f32_16x16x32_bf16 v[24:27], v[128:131], v[164:167], v[24:27]
    ds_read_b128 v[176:179], v197 offset:2944
    v_mfma_f32_16x16x32_bf16 v[20:23], v[132:135], v[156:159], v[20:23]
    s_nop 0
    ds_read_b64 v[144:145], v196 offset:1152
    ds_read_b64_tr_b16 a[164:165], v245 offset:2048
    v_mfma_f32_16x16x32_bf16 v[24:27], v[132:135], v[160:163], v[24:27]
    ds_read_b64 v[146:147], v196 offset:1160
    v_mfma_f32_16x16x32_bf16 v[28:31], v[132:135], v[164:167], v[28:31]
    ds_read_b64_tr_b16 a[166:167], v245 offset:3072
    ds_read_b64_tr_b16 a[40:41], v244 offset:4096
    s_waitcnt lgkmcnt(12)
    s_nop 0
    v_mfma_f32_16x16x32_bf16 v[24:27], v[124:127], v[168:171], v[24:27]
    ds_read_b64_tr_b16 a[42:43], v244 offset:5120
    v_mfma_f32_16x16x32_bf16 v[28:31], v[128:131], v[168:171], v[28:31]
    ds_read_b128 v[180:183], v197 offset:3456
    ds_read_b64_tr_b16 a[168:169], v245 offset:4096
    v_mfma_f32_16x16x32_bf16 v[32:35], v[132:135], v[168:171], v[32:35]
    ds_read_b64 v[148:149], v196 offset:640
    v_mfma_f32_16x16x32_bf16 v[24:27], v[136:139], v[156:159], v[24:27]
    ds_read_b64 v[150:151], v196 offset:648
    ds_read_b64_tr_b16 a[170:171], v245 offset:5120
    v_mfma_f32_16x16x32_bf16 v[28:31], v[136:139], v[160:163], v[28:31]
    ds_read_b64_tr_b16 a[44:45], v244 offset:6144
    v_mfma_f32_16x16x32_bf16 v[32:35], v[136:139], v[164:167], v[32:35]
    ds_read_b128 v[184:187], v197 offset:3968
    ds_read_b64_tr_b16 a[46:47], v244 offset:7168
    v_mfma_f32_16x16x32_bf16 v[36:39], v[136:139], v[168:171], v[36:39]
    ds_read_b64 v[152:153], v196 offset:128
    s_waitcnt lgkmcnt(14)
    v_mfma_f32_16x16x32_bf16 v[28:31], v[124:127], v[172:175], v[28:31]
    ds_read_b64 v[154:155], v196 offset:136
    ds_read_b64_tr_b16 a[172:173], v245 offset:6144
    v_mfma_f32_16x16x32_bf16 v[32:35], v[128:131], v[172:175], v[32:35]
    ds_read_b128 v[92:95], v197 offset:320
    v_mfma_f32_16x16x32_bf16 v[36:39], v[132:135], v[172:175], v[36:39]
    s_nop 0
    ds_read_b64 v[60:61], v196 offset:3648
    ds_read_b64_tr_b16 a[174:175], v245 offset:7168
    v_mfma_f32_16x16x32_bf16 v[40:43], v[136:139], v[172:175], v[40:43]
    s_waitcnt lgkmcnt(0)
    s_add_u32 m0, s60, 0
    s_add_u32 s15, s14, 1146880
    buffer_load_dwordx4 v240, s[52:55], s15 offen offset:0  lds
    v_mfma_f32_16x16x32_bf16 v[28:31], v[140:143], v[156:159], v[28:31]
    ds_read_b64 v[62:63], v196 offset:3656
    s_waitcnt vmcnt(11)
    ds_read_b64_tr_b16 a[48:49], v244 offset:8192
    v_mfma_f32_16x16x32_bf16 v[32:35], v[140:143], v[160:163], v[32:35]
    ds_read_b128 v[96:99], v197 offset:832
    v_mfma_f32_16x16x32_bf16 v[36:39], v[140:143], v[164:167], v[36:39]
    buffer_load_dwordx4 v241, s[52:55], s15 offen offset:1024  lds
    ds_read_b64_tr_b16 a[50:51], v244 offset:9216
    v_mfma_f32_16x16x32_bf16 v[40:43], v[140:143], v[168:171], v[40:43]
    s_nop 0
    ds_read_b64 v[64:65], v196 offset:3136
    v_mfma_f32_16x16x32_bf16 v[32:35], v[124:127], v[176:179], v[32:35]
    ds_read_b64 v[66:67], v196 offset:3144
    ds_read_b64_tr_b16 a[176:177], v245 offset:8192
    v_mfma_f32_16x16x32_bf16 v[36:39], v[128:131], v[176:179], v[36:39]
    buffer_load_dwordx4 v242, s[52:55], s15 offen offset:2048  lds
    v_mfma_f32_16x16x32_bf16 v[40:43], v[132:135], v[176:179], v[40:43]
    ds_read_b128 v[100:103], v197 offset:1344
    ds_read_b64_tr_b16 a[178:179], v245 offset:9216
    v_mfma_f32_16x16x32_bf16 v[32:35], v[144:147], v[156:159], v[32:35]
    ds_read_b64 v[68:69], v196 offset:2624
    v_mfma_f32_16x16x32_bf16 v[36:39], v[144:147], v[160:163], v[36:39]
    buffer_load_dwordx4 v243, s[52:55], s15 offen offset:3072  lds
    ds_read_b64_tr_b16 a[52:53], v244 offset:10240
    v_mfma_f32_16x16x32_bf16 v[40:43], v[144:147], v[164:167], v[40:43]
    ds_read_b64 v[70:71], v196 offset:2632
    v_mfma_f32_16x16x32_bf16 v[36:39], v[124:127], v[180:183], v[36:39]
    ds_read_b128 v[104:107], v197 offset:1856
    ds_read_b64_tr_b16 a[54:55], v244 offset:11264
    v_mfma_f32_16x16x32_bf16 v[40:43], v[128:131], v[180:183], v[40:43]
    s_add_u32 m0, s60, 4096
    s_add_u32 s15, s14, 1261568
    buffer_load_dwordx4 v240, s[52:55], s15 offen offset:0  lds
    v_mfma_f32_16x16x32_bf16 v[36:39], v[148:151], v[156:159], v[36:39]
    ds_read_b64 v[72:73], v196 offset:2112
    ds_read_b64_tr_b16 a[180:181], v245 offset:10240
    v_mfma_f32_16x16x32_bf16 v[40:43], v[148:151], v[160:163], v[40:43]
    ds_read_b64 v[74:75], v196 offset:2120
    v_mfma_f32_16x16x32_bf16 v[40:43], v[124:127], v[184:187], v[40:43]
    buffer_load_dwordx4 v241, s[52:55], s15 offen offset:1024  lds
    ds_read_b64_tr_b16 a[182:183], v245 offset:11264
    v_mfma_f32_16x16x32_bf16 v[40:43], v[152:155], v[156:159], v[40:43]
    ds_read_b128 v[108:111], v197 offset:2368
    s_waitcnt lgkmcnt(14)
    v_mfma_f32_16x16x32_bf16 v[12:15], v[60:63], v[92:95], v[12:15]
    ds_read_b64 v[76:77], v196 offset:1600
    ds_read_b64_tr_b16 a[56:57], v244 offset:12288
    s_waitcnt lgkmcnt(14)
    v_mfma_f32_16x16x32_bf16 v[16:19], v[60:63], v[96:99], v[16:19]
    buffer_load_dwordx4 v242, s[52:55], s15 offen offset:2048  lds
    v_mfma_f32_16x16x32_bf16 v[16:19], v[64:67], v[92:95], v[16:19]
    ds_read_b64 v[78:79], v196 offset:1608
    ds_read_b64_tr_b16 a[58:59], v244 offset:13312
    v_mfma_f32_16x16x32_bf16 v[20:23], v[64:67], v[96:99], v[20:23]
    ds_read_b128 v[112:115], v197 offset:2880
    s_waitcnt lgkmcnt(12)
    v_mfma_f32_16x16x32_bf16 v[20:23], v[60:63], v[100:103], v[20:23]
    buffer_load_dwordx4 v243, s[52:55], s15 offen offset:3072  lds
    ds_read_b64_tr_b16 a[184:185], v245 offset:12288
    s_nop 0
    v_mfma_f32_16x16x32_bf16 v[24:27], v[64:67], v[100:103], v[24:27]
    ds_read_b64 v[80:81], v196 offset:1088
    v_mfma_f32_16x16x32_bf16 v[20:23], v[68:71], v[92:95], v[20:23]
    ds_read_b64 v[82:83], v196 offset:1096
    ds_read_b64_tr_b16 a[186:187], v245 offset:13312
    v_mfma_f32_16x16x32_bf16 v[24:27], v[68:71], v[96:99], v[24:27]
    ds_read_b128 v[156:159], v197 offset:256
    v_mfma_f32_16x16x32_bf16 v[28:31], v[68:71], v[100:103], v[28:31]
    ds_read_b64 v[124:125], v196 offset:3584
    ds_read_b64_tr_b16 a[60:61], v244 offset:14336
    s_waitcnt lgkmcnt(14)
    v_mfma_f32_16x16x32_bf16 v[24:27], v[60:63], v[104:107], v[24:27]
    ds_read_b64 v[126:127], v196 offset:3592
    v_mfma_f32_16x16x32_bf16 v[28:31], v[64:67], v[104:107], v[28:31]
    ds_read_b128 v[160:163], v197 offset:768
    ds_read_b64_tr_b16 a[62:63], v244 offset:15360
    s_nop 0
    v_mfma_f32_16x16x32_bf16 v[32:35], v[68:71], v[104:107], v[32:35]
    ds_read_b64 v[128:129], v196 offset:3072
    v_mfma_f32_16x16x32_bf16 v[24:27], v[72:75], v[92:95], v[24:27]
    ds_read_b64 v[130:131], v196 offset:3080
    ds_read_b64_tr_b16 a[188:189], v245 offset:14336
    v_mfma_f32_16x16x32_bf16 v[28:31], v[72:75], v[96:99], v[28:31]
    ds_read_b128 v[164:167], v197 offset:1280
    v_mfma_f32_16x16x32_bf16 v[32:35], v[72:75], v[100:103], v[32:35]
    ds_read_b64 v[132:133], v196 offset:2560
    ds_read_b64_tr_b16 a[190:191], v245 offset:15360
    s_waitcnt lgkmcnt(14)
    v_mfma_f32_16x16x32_bf16 v[28:31], v[60:63], v[108:111], v[28:31]
    ds_read_b64 v[134:135], v196 offset:2568
    v_mfma_f32_16x16x32_bf16 v[32:35], v[64:67], v[108:111], v[32:35]
    ds_read_b128 v[168:171], v197 offset:1792
    s_waitcnt vmcnt(8)
    ds_read_b64_tr_b16 a[64:65], v246 offset:0
    v_mfma_f32_16x16x32_bf16 v[28:31], v[76:79], v[92:95], v[28:31]
    s_waitcnt lgkmcnt(3)
    s_add_u32 m0, s60, 8192
    s_add_u32 s15, s14, 1376256
    buffer_load_dwordx4 v240, s[52:55], s15 offen offset:0  lds
    v_mfma_f32_16x16x32_bf16 v[32:35], v[76:79], v[96:99], v[32:35]
    ds_read_b64 v[136:137], v196 offset:2048
    ds_read_b64_tr_b16 a[66:67], v246 offset:1024
    s_nop 0
    v_mfma_f32_16x16x32_bf16 v[32:35], v[60:63], v[112:115], v[32:35]
    ds_read_b64 v[138:139], v196 offset:2056
    v_mfma_f32_16x16x32_bf16 v[32:35], v[80:83], v[92:95], v[32:35]
    buffer_load_dwordx4 v241, s[52:55], s15 offen offset:1024  lds
    ds_read_b64_tr_b16 a[192:193], v247 offset:0
    v_mfma_f32_16x16x32_bf16 v[12:15], v[124:127], v[156:159], v[12:15]
    ds_read_b128 v[172:175], v197 offset:2304
    v_mfma_f32_16x16x32_bf16 v[16:19], v[124:127], v[160:163], v[16:19]
    ds_read_b64 v[140:141], v196 offset:1536
    ds_read_b64_tr_b16 a[194:195], v247 offset:1024
    v_mfma_f32_16x16x32_bf16 v[16:19], v[128:131], v[156:159], v[16:19]
    buffer_load_dwordx4 v242, s[52:55], s15 offen offset:2048  lds
    v_mfma_f32_16x16x32_bf16 v[20:23], v[128:131], v[160:163], v[20:23]
    ds_read_b64 v[142:143], v196 offset:1544
    ds_read_b64_tr_b16 a[68:69], v246 offset:2048
    s_waitcnt lgkmcnt(11)
    s_nop 0
    v_mfma_f32_16x16x32_bf16 v[20:23], v[124:127], v[164:167], v[20:23]
    ds_read_b128 v[176:179], v197 offset:2816
    v_mfma_f32_16x16x32_bf16 v[24:27], v[128:131], v[164:167], v[24:27]
    buffer_load_dwordx4 v243, s[52:55], s15 offen offset:3072  lds
    v_cndmask_b32 v232, v16, v12, s[70:71]
    v_mfma_f32_16x16x32_bf16 v[20:23], v[132:135], v[156:159], v[20:23]
    ds_read_b64 v[144:145], v196 offset:1024
    v_cndmask_b32 v233, v17, v13, s[70:71]
    v_mfma_f32_16x16x32_bf16 v[24:27], v[132:135], v[160:163], v[24:27]
    ds_read_b64 v[146:147], v196 offset:1032
    v_cndmask_b32 v234, v18, v14, s[70:71]
    s_waitcnt lgkmcnt(9)
    v_mfma_f32_16x16x32_bf16 v[24:27], v[124:127], v[168:171], v[24:27]
    s_add_u32 m0, s60, 12288
    s_add_u32 s15, s14, 1490944
    buffer_load_dwordx4 v240, s[52:55], s15 offen offset:0  lds
    s_nop 0
    v_cndmask_b32 v235, v19, v15, s[70:71]
    v_mfma_f32_16x16x32_bf16 v[24:27], v[136:139], v[156:159], v[24:27]
    ds_write_b128 v199, v[232:235] offset:0
    v_cndmask_b32 v12, v12, v16, s[70:71]
    v_mfma_f32_16x16x32_bf16 v[28:31], v[132:135], v[164:167], v[28:31]
    ds_read_b128 v[116:119], v197 offset:3392
    v_cndmask_b32 v13, v13, v17, s[70:71]
    v_mfma_f32_16x16x32_bf16 v[28:31], v[128:131], v[168:171], v[28:31]
    buffer_load_dwordx4 v241, s[52:55], s15 offen offset:1024  lds
    v_cndmask_b32 v14, v14, v18, s[70:71]
    v_mfma_f32_16x16x32_bf16 v[32:35], v[132:135], v[168:171], v[32:35]
    ds_read_b64 v[84:85], v196 offset:576
    v_cndmask_b32 v15, v15, v19, s[70:71]
    v_mfma_f32_16x16x32_bf16 v[28:31], v[136:139], v[160:163], v[28:31]
    ds_read_b64 v[86:87], v196 offset:584
    v_add_f32_e64 v12, v12, v44
    v_mfma_f32_16x16x32_bf16 v[32:35], v[136:139], v[164:167], v[32:35]
    buffer_load_dwordx4 v242, s[52:55], s15 offen offset:2048  lds
    v_add_f32 v13, v13, v46
    s_waitcnt lgkmcnt(8)
    v_mfma_f32_16x16x32_bf16 v[28:31], v[124:127], v[172:175], v[28:31]
    ds_read_b128 v[120:123], v197 offset:3904
    v_add_f32 v14, v14, v45
    v_mfma_f32_16x16x32_bf16 v[32:35], v[128:131], v[172:175], v[32:35]
    ds_read_b64 v[88:89], v196 offset:64
    v_add_f32 v15, v15, v47
    v_mfma_f32_16x16x32_bf16 v[28:31], v[140:143], v[156:159], v[28:31]
    buffer_load_dwordx4 v243, s[52:55], s15 offen offset:3072  lds
    v_cndmask_b32 v236, v24, v20, s[70:71]
    v_mfma_f32_16x16x32_bf16 v[32:35], v[140:143], v[160:163], v[32:35]
    ds_read_b64 v[90:91], v196 offset:72
    v_cndmask_b32 v237, v25, v21, s[70:71]
    s_waitcnt lgkmcnt(7)
    v_mfma_f32_16x16x32_bf16 v[32:35], v[124:127], v[176:179], v[32:35]
    s_nop 0
    ds_read_b64_tr_b16 a[70:71], v246 offset:3072
    v_cndmask_b32 v238, v26, v22, s[70:71]
    v_mfma_f32_16x16x32_bf16 v[32:35], v[144:147], v[156:159], v[32:35]
    ds_read_b64_tr_b16 a[196:197], v247 offset:2048
    v_cndmask_b32 v239, v27, v23, s[70:71]
    v_mfma_f32_16x16x32_bf16 v[36:39], v[72:75], v[104:107], v[36:39]
    ds_write_b128 v199, v[236:239] offset:2048
    v_cndmask_b32 v20, v20, v24, s[70:71]
    v_mfma_f32_16x16x32_bf16 v[36:39], v[68:71], v[108:111], v[36:39]
    ds_read_b64_tr_b16 a[198:199], v247 offset:3072
    v_cndmask_b32 v21, v21, v25, s[70:71]
    v_mfma_f32_16x16x32_bf16 v[40:43], v[72:75], v[108:111], v[40:43]
    ds_read_b64_tr_b16 a[72:73], v246 offset:4096
    v_cndmask_b32 v22, v22, v26, s[70:71]
    v_mfma_f32_16x16x32_bf16 v[36:39], v[76:79], v[100:103], v[36:39]
    ds_read_b64_tr_b16 a[74:75], v246 offset:5120
    v_cndmask_b32 v23, v23, v27, s[70:71]
    v_mfma_f32_16x16x32_bf16 v[40:43], v[76:79], v[104:107], v[40:43]
    ds_read_b128 v[180:183], v197 offset:3328
    v_add_f32 v20, v20, v48
    v_mfma_f32_16x16x32_bf16 v[36:39], v[64:67], v[112:115], v[36:39]
    ds_read_b64 v[148:149], v196 offset:512
    v_add_f32 v21, v21, v50
    v_mfma_f32_16x16x32_bf16 v[40:43], v[68:71], v[112:115], v[40:43]
    ds_read_b64 v[150:151], v196 offset:520
    v_add_f32 v22, v22, v49
    v_mfma_f32_16x16x32_bf16 v[36:39], v[80:83], v[96:99], v[36:39]
    ds_read_b64_tr_b16 a[200:201], v247 offset:4096
    v_add_f32_e64 v23, v23, v51
    v_mfma_f32_16x16x32_bf16 v[40:43], v[80:83], v[100:103], v[40:43]
    ds_read_b128 v[184:187], v197 offset:3840
    v_cndmask_b32 v232, v32, v28, s[70:71]
    s_waitcnt lgkmcnt(14)
    v_mfma_f32_16x16x32_bf16 v[36:39], v[60:63], v[116:119], v[36:39]
    ds_read_b64 v[152:153], v196 offset:0
    v_cndmask_b32 v233, v33, v29, s[70:71]
    v_mfma_f32_16x16x32_bf16 v[40:43], v[64:67], v[116:119], v[40:43]
    ds_read_b64 v[154:155], v196 offset:8
    v_cndmask_b32 v234, v34, v30, s[70:71]
    v_mfma_f32_16x16x32_bf16 v[36:39], v[84:87], v[92:95], v[36:39]
    ds_read_b64_tr_b16 a[202:203], v247 offset:5120
    v_cndmask_b32 v235, v35, v31, s[70:71]
    v_mfma_f32_16x16x32_bf16 v[40:43], v[84:87], v[96:99], v[40:43]
    ds_write_b128 v199, v[232:235] offset:4096
    v_cndmask_b32 v28, v28, v32, s[70:71]
    s_waitcnt lgkmcnt(14)
    v_mfma_f32_16x16x32_bf16 v[40:43], v[60:63], v[120:123], v[40:43]
    ds_read_b64_tr_b16 a[76:77], v246 offset:6144
    v_cndmask_b32 v29, v29, v33, s[70:71]
    v_mfma_f32_16x16x32_bf16 v[40:43], v[88:91], v[92:95], v[40:43]
    s_nop 0
    ds_read_b64_tr_b16 a[78:79], v246 offset:7168
    v_cndmask_b32 v30, v30, v34, s[70:71]
    v_mfma_f32_16x16x32_bf16 v[36:39], v[136:139], v[168:171], v[36:39]
    ds_read_b64_tr_b16 a[204:205], v247 offset:6144
    v_cndmask_b32 v31, v31, v35, s[70:71]
    v_mfma_f32_16x16x32_bf16 v[36:39], v[132:135], v[172:175], v[36:39]
    ds_read_b64_tr_b16 a[206:207], v247 offset:7168
    v_add_f32_e64 v28, v28, v52
    v_mfma_f32_16x16x32_bf16 v[40:43], v[136:139], v[172:175], v[40:43]
    v_add_f32 v29, v29, v54
    v_add_f32 v30, v30, v53
    v_mfma_f32_16x16x32_bf16 v[36:39], v[140:143], v[164:167], v[36:39]
    v_add_f32 v31, v31, v55
    v_and_b32 v230, 3, v0
    v_mfma_f32_16x16x32_bf16 v[40:43], v[140:143], v[168:171], v[40:43]
    s_waitcnt lgkmcnt(0)
    s_add_u32 m0, s61, 0
    s_add_u32 s15, s14, 1605632
    buffer_load_dwordx4 v240, s[52:55], s15 offen offset:0  lds
    v_lshlrev_b32_e64 v230, 2, v230
    v_mfma_f32_16x16x32_bf16 v[36:39], v[128:131], v[176:179], v[36:39]
    v_mfma_f32_16x16x32_bf16 v[40:43], v[132:135], v[176:179], v[40:43]
    v_mfma_f32_16x16x32_bf16 v[36:39], v[144:147], v[160:163], v[36:39]
    buffer_load_dwordx4 v241, s[52:55], s15 offen offset:1024  lds
    v_mfma_f32_16x16x32_bf16 v[40:43], v[144:147], v[164:167], v[40:43]
    v_mfma_f32_16x16x32_bf16 v[36:39], v[124:127], v[180:183], v[36:39]
    v_mfma_f32_16x16x32_bf16 v[40:43], v[128:131], v[180:183], v[40:43]
    buffer_load_dwordx4 v242, s[52:55], s15 offen offset:2048  lds
    v_mfma_f32_16x16x32_bf16 v[36:39], v[148:151], v[156:159], v[36:39]
    v_mfma_f32_16x16x32_bf16 v[40:43], v[148:151], v[160:163], v[40:43]
    v_mfma_f32_16x16x32_bf16 v[40:43], v[124:127], v[184:187], v[40:43]
    buffer_load_dwordx4 v243, s[52:55], s15 offen offset:3072  lds
    v_mfma_f32_16x16x32_bf16 v[40:43], v[152:155], v[156:159], v[40:43]
    s_nop 7
    v_cndmask_b32 v236, v40, v36, s[70:71]
    s_nop 0
    v_cndmask_b32 v237, v41, v37, s[70:71]
    v_cndmask_b32 v238, v42, v38, s[70:71]
    v_cndmask_b32 v239, v43, v39, s[70:71]
    ds_write_b128 v199, v[236:239] offset:6144
    v_cndmask_b32 v36, v36, v40, s[70:71]
    v_cndmask_b32 v37, v37, v41, s[70:71]
    v_cndmask_b32 v38, v38, v42, s[70:71]
    v_cndmask_b32 v39, v39, v43, s[70:71]
    v_add_f32 v36, v36, v56
    v_add_f32 v37, v37, v58
    v_add_f32 v38, v38, v57
    v_add_f32 v39, v39, v59
    s_waitcnt lgkmcnt(0)
    s_barrier
    ds_read_b128 v[204:207], v254 offset:0
    ds_read_b128 v[208:211], v254 offset:2048
    ds_read_b128 v[212:215], v254 offset:4096
    ds_read_b128 v[216:219], v254 offset:6144
    ds_read_b32 v229, v230 offset:60192
    s_waitcnt lgkmcnt(4)
    v_add_f32 v12, v12, v204
    v_add_f32 v13, v13, v205
    v_add_f32 v14, v14, v206
    v_add_f32 v15, v15, v207
    v_cvt_pk_bf16_f32 v4, v12, v13
    v_cvt_pk_bf16_f32 v5, v14, v15
    s_waitcnt lgkmcnt(3)
    v_add_f32 v20, v20, v208
    v_add_f32 v21, v21, v209
    v_add_f32 v22, v22, v210
    v_add_f32 v23, v23, v211
    v_cvt_pk_bf16_f32 v6, v20, v21
    v_cvt_pk_bf16_f32 v7, v22, v23
    s_nop 1
    v_permlane16_swap_b32 v4, v6
    v_permlane16_swap_b32 v5, v7
    global_store_dwordx4 v228, v[4:7], s[44:45] offset:0 sc1
    s_waitcnt lgkmcnt(2)
    v_add_f32 v28, v28, v212
    v_add_f32 v29, v29, v213
    v_add_f32 v30, v30, v214
    v_add_f32 v31, v31, v215
    v_cvt_pk_bf16_f32 v8, v28, v29
    v_cvt_pk_bf16_f32 v9, v30, v31
    s_waitcnt lgkmcnt(1)
    v_add_f32 v36, v36, v216
    v_add_f32 v37, v37, v217
    v_add_f32 v38, v38, v218
    v_add_f32 v39, v39, v219
    v_cvt_pk_bf16_f32 v10, v36, v37
    v_cvt_pk_bf16_f32 v11, v38, v39
    s_nop 1
    v_permlane16_swap_b32 v8, v10
    v_permlane16_swap_b32 v9, v11
    global_store_dwordx4 v228, v[8:11], s[44:45] offset:2048 sc1
    s_waitcnt lgkmcnt(0)
    s_cmp_lg_u32 s46, 0
    s_barrier
    s_cbranch_scc1 L_nohint_9
    s_mov_b64 exec, 15
    global_store_dwordx4 v220, v[224:227], s[44:45] sc1
    s_mov_b64 exec, -1
L_nohint_9:
    s_mul_i32 s65, s49, 14336
    s_mul_i32 s66, s46, 7168
    s_add_u32 s65, s65, s66
    s_add_u32 s65, s65, 4194304
    v_min_u32 v221, 880, v252
    s_nop 0
    v_lshl_add_u32 v221, v221, 3, s65
    s_lshl_b32 s65, s50, 7
    s_add_u32 s65, s65, 45056
    v_writelane_b32 v221, s65, 63
    global_load_dword v253, v221, s[44:45] sc1
    s_lshl_b32 s64, s2, 6
    s_lshl_b32 s65, s46, 2
    s_add_u32 s64, s64, s65
    s_add_u32 s64, s64, 131072
    v_mov_b32 v2, s64
    v_mov_b32 v3, s4
    v_mov_b32 v12, 0x3f803f80
    s_mov_b32 s70, -1
    s_mov_b32 s71, 0
    s_mov_b64 s[34:35], -1
    s_mov_b32 s64, 0x00100001
    s_mov_b32 s65, 0x00100001
    v_cndmask_b32 v8, 0, v12, s[64:65]
    v_cndmask_b32 v9, 0, v12, s[64:65]
    v_cndmask_b32 v10, 0, v12, s[64:65]
    s_nop 0
    v_cndmask_b32 v11, 0, v12, s[64:65]
    s_cmp_lg_u32 s46, 3
    s_cbranch_scc1 L_w012_10
    v_lshlrev_b32_e64 v232, 2, v252
    v_add_u32 v235, 77824, v232
    v_add_u32 v234, 73728, v232
    v_add_u32 v233, 69632, v232
    v_add_u32 v232, 65536, v232
    s_add_u32 m0, s61, 4096
    s_add_u32 s15, s14, 1720320
    buffer_load_dwordx4 v240, s[52:55], s15 offen offset:0  lds
    buffer_load_dwordx4 v241, s[52:55], s15 offen offset:1024  lds
    buffer_load_dwordx4 v242, s[52:55], s15 offen offset:2048  lds
    buffer_load_dwordx4 v243, s[52:55], s15 offen offset:3072  lds
    s_waitcnt vmcnt(19)
    ds_read_b64_tr_b16 a[80:81], v244 offset:0
    ds_read_b64_tr_b16 a[82:83], v244 offset:1024
    s_nop 0
    ds_read_b64_tr_b16 a[84:85], v244 offset:2048
    ds_read_b64_tr_b16 a[86:87], v244 offset:3072
    ds_read_b64_tr_b16 a[88:89], v244 offset:4096
    ds_read_b64_tr_b16 a[90:91], v244 offset:5120
    ds_read_b64_tr_b16 a[92:93], v244 offset:6144
    ds_read_b64_tr_b16 a[94:95], v244 offset:7168
    s_waitcnt vmcnt(11)
    ds_read_b64_tr_b16 a[96:97], v244 offset:8192
    s_nop 0
    ds_read_b64_tr_b16 a[98:99], v244 offset:9216
    ds_read_b64_tr_b16 a[100:101], v244 offset:10240
    ds_read_b64_tr_b16 a[102:103], v244 offset:11264
    ds_read_b64_tr_b16 a[104:105], v244 offset:12288
    ds_read_b64_tr_b16 a[106:107], v244 offset:13312
    ds_read_b64_tr_b16 a[108:109], v244 offset:14336
    ds_read_b64_tr_b16 a[110:111], v244 offset:15360
    s_mov_b32 s52, s38
    s_mov_b32 s53, s39
    s_lshl_b32 s14, s51, 7
    s_mul_i32 s64, s51, 28672
    s_lshl_b32 s65, s3, 12
    s_add_u32 s16, s64, s65
    s_add_u32 s17, s16, 4096
    s_add_u32 s65, s64, 225280
    s_sub_u32 s66, s65, 229376
    s_min_u32 s65, s65, s66
    s_cmp_eq_u32 s46, 3
    s_cselect_b32 s17, s65, s17
    s_mul_i32 s65, s46, 49152
    s_add_u32 s64, s64, s65
    s_add_u32 s65, s64, 28672
    s_sub_u32 s66, s65, 229376
    s_min_u32 s18, s65, s66
    s_add_u32 s65, s64, 32768
    s_sub_u32 s66, s65, 229376
    s_min_u32 s19, s65, s66
    s_add_u32 s65, s64, 36864
    s_sub_u32 s66, s65, 229376
    s_min_u32 s20, s65, s66
    s_add_u32 s65, s64, 40960
    s_sub_u32 s66, s65, 229376
    s_min_u32 s21, s65, s66
    s_add_u32 s65, s64, 45056
    s_sub_u32 s66, s65, 229376
    s_min_u32 s22, s65, s66
    s_add_u32 s65, s64, 49152
    s_sub_u32 s66, s65, 229376
    s_min_u32 s23, s65, s66
    s_nop 0
    s_add_u32 s65, s64, 53248
    s_sub_u32 s66, s65, 229376
    s_min_u32 s24, s65, s66
    s_add_u32 s65, s64, 57344
    s_sub_u32 s66, s65, 229376
    s_min_u32 s25, s65, s66
    s_add_u32 s65, s64, 61440
    s_sub_u32 s66, s65, 229376
    s_min_u32 s26, s65, s66
    s_nop 0
    s_add_u32 s65, s64, 65536
    s_sub_u32 s66, s65, 229376
    s_min_u32 s27, s65, s66
    s_add_u32 s65, s64, 69632
    s_sub_u32 s66, s65, 229376
    s_min_u32 s28, s65, s66
    s_add_u32 s65, s64, 73728
    s_sub_u32 s66, s65, 229376
    s_min_u32 s29, s65, s66
    s_nop 0
    v_lshl_add_u32 v240, v248, 10, v249
    v_add_u32 v241, 7168, v240
    v_add_u32 v242, 14336, v240
    v_add_u32 v243, 21504, v240
    s_waitcnt lgkmcnt(0)
    v_mfma_f32_16x16x32_bf16 v[96:99], v[8:11], a[0:3], 0
    s_add_u32 m0, s60, 0
    s_lshl3_add_u32 s15, s16, s14
    buffer_load_dwordx4 v240, s[52:55], s15 offen offset:0  lds
    s_nop 0
    v_mfma_f32_16x16x32_bf16 v[96:99], v[8:11], a[4:7], v[96:99]
    buffer_load_dwordx4 v241, s[52:55], s15 offen offset:1024  lds
    v_mfma_f32_16x16x32_bf16 v[96:99], v[8:11], a[8:11], v[96:99]
    buffer_load_dwordx4 v242, s[52:55], s15 offen offset:2048  lds
    v_mfma_f32_16x16x32_bf16 v[96:99], v[8:11], a[12:15], v[96:99]
    buffer_load_dwordx4 v243, s[52:55], s15 offen offset:3072  lds
    v_mfma_f32_16x16x32_bf16 v[96:99], v[8:11], a[16:19], v[96:99]
    s_add_u32 m0, s60, 4096
    s_lshl3_add_u32 s15, s17, s14
    buffer_load_dwordx4 v240, s[52:55], s15 offen offset:0  lds
    v_mfma_f32_16x16x32_bf16 v[96:99], v[8:11], a[20:23], v[96:99]
    buffer_load_dwordx4 v241, s[52:55], s15 offen offset:1024  lds
    v_mfma_f32_16x16x32_bf16 v[96:99], v[8:11], a[24:27], v[96:99]
    buffer_load_dwordx4 v242, s[52:55], s15 offen offset:2048  lds
    v_mfma_f32_16x16x32_bf16 v[96:99], v[8:11], a[28:31], v[96:99]
    buffer_load_dwordx4 v243, s[52:55], s15 offen offset:3072  lds
    s_nop 0
    v_mfma_f32_16x16x32_bf16 v[96:99], v[8:11], a[32:35], v[96:99]
    s_add_u32 m0, s60, 8192
    s_lshl3_add_u32 s15, s18, s14
    buffer_load_dwordx4 v240, s[52:55], s15 offen offset:0  lds
    v_mfma_f32_16x16x32_bf16 v[96:99], v[8:11], a[36:39], v[96:99]
    buffer_load_dwordx4 v241, s[52:55], s15 offen offset:1024  lds
    v_mfma_f32_16x16x32_bf16 v[96:99], v[8:11], a[40:43], v[96:99]
    buffer_load_dwordx4 v242, s[52:55], s15 offen offset:2048  lds
    s_nop 0
    v_mfma_f32_16x16x32_bf16 v[96:99], v[8:11], a[44:47], v[96:99]
    buffer_load_dwordx4 v243, s[52:55], s15 offen offset:3072  lds
    v_mfma_f32_16x16x32_bf16 v[96:99], v[8:11], a[48:51], v[96:99]
    s_add_u32 m0, s60, 12288
    s_lshl3_add_u32 s15, s19, s14
    buffer_load_dwordx4 v240, s[52:55], s15 offen offset:0  lds
    v_mfma_f32_16x16x32_bf16 v[96:99], v[8:11], a[52:55], v[96:99]
    buffer_load_dwordx4 v241, s[52:55], s15 offen offset:1024  lds
    s_nop 0
    v_mfma_f32_16x16x32_bf16 v[96:99], v[8:11], a[56:59], v[96:99]
    buffer_load_dwordx4 v242, s[52:55], s15 offen offset:2048  lds
    v_mfma_f32_16x16x32_bf16 v[96:99], v[8:11], a[60:63], v[96:99]
    buffer_load_dwordx4 v243, s[52:55], s15 offen offset:3072  lds
    v_mfma_f32_16x16x32_bf16 v[96:99], v[8:11], a[64:67], v[96:99]
    v_mfma_f32_16x16x32_bf16 v[96:99], v[8:11], a[68:71], v[96:99]
    v_mfma_f32_16x16x32_bf16 v[96:99], v[8:11], a[72:75], v[96:99]
    v_mfma_f32_16x16x32_bf16 v[96:99], v[8:11], a[76:79], v[96:99]
    v_mfma_f32_16x16x32_bf16 v[96:99], v[8:11], a[80:83], v[96:99]
    v_mfma_f32_16x16x32_bf16 v[96:99], v[8:11], a[84:87], v[96:99]
    v_mfma_f32_16x16x32_bf16 v[96:99], v[8:11], a[88:91], v[96:99]
    v_mfma_f32_16x16x32_bf16 v[96:99], v[8:11], a[92:95], v[96:99]
    v_mfma_f32_16x16x32_bf16 v[96:99], v[8:11], a[96:99], v[96:99]
    v_mfma_f32_16x16x32_bf16 v[96:99], v[8:11], a[100:103], v[96:99]
    v_mfma_f32_16x16x32_bf16 v[96:99], v[8:11], a[104:107], v[96:99]
    v_mfma_f32_16x16x32_bf16 v[96:99], v[8:11], a[108:111], v[96:99]
    s_waitcnt vmcnt(16)
    global_load_dwordx4 v[64:67], v232, s[44:45] sc1
    global_load_dwordx4 v[68:71], v233, s[44:45] sc1
    global_load_dwordx4 v[72:75], v234, s[44:45] sc1
    global_load_dwordx4 v[76:79], v235, s[44:45] sc1
    ds_read_b64_tr_b16 a[112:113], v246 offset:0
    ds_read_b64_tr_b16 a[114:115], v246 offset:1024
    ds_read_b64_tr_b16 a[116:117], v246 offset:2048
    s_nop 0
    ds_read_b64_tr_b16 a[118:119], v246 offset:3072
    ds_read_b64_tr_b16 a[120:121], v246 offset:4096
    ds_read_b64_tr_b16 a[122:123], v246 offset:5120
    ds_read_b64_tr_b16 a[124:125], v246 offset:6144
    ds_read_b64_tr_b16 a[126:127], v246 offset:7168
    s_lshl_b32 s64, s46, 5
    v_xor_b32 v244, s64, v250
    v_add_u32 v246, s61, v244
    v_add_u32 v244, s60, v244
    v_xor_b32 v245, s64, v251
    v_add_u32 v247, s61, v245
    v_add_u32 v245, s60, v245
    v_lshl_add_u32 v36, v248, 12, v249
    v_add_u32 v37, 31744, v36
    v_add_u32 v38, 63488, v36
    v_add_u32 v39, 95232, v36
    s_lshl_b32 s68, s46, 12
    s_lshl_b32 s69, s46, 17
    s_lshl_b32 s64, s50, 7
    s_add_u32 s69, s69, s64
    v_and_b32 v35, 31, v0
    v_lshlrev_b32_e64 v35, 2, v35
    v_add_u32 v34, 90112, v35
    s_mul_i32 s64, s50, 229376
    s_add_u32 s64, s64, 4194304
    s_add_u32 s65, s64, s16
    s_add_u32 s65, s65, 4096
    v_add_u32 v236, s65, v252
    s_add_u32 s36, s44, s64
    s_addc_u32 s37, s45, 0
    s_mov_b32 s38, 229376
    s_mov_b32 s39, 0x20000
    v_mov_b32 v26, 0
    v_mov_b32 v27, 0
    v_mov_b32 v30, 0
    v_mov_b32 v31, 0
    v_add_u32_e64 v237, 1, v3
    s_waitcnt lgkmcnt(0)
    v_mfma_f32_16x16x32_bf16 v[96:99], v[8:11], a[112:115], v[96:99]
    v_mfma_f32_16x16x32_bf16 v[96:99], v[8:11], a[116:119], v[96:99]
    v_mfma_f32_16x16x32_bf16 v[96:99], v[8:11], a[120:123], v[96:99]
    v_mfma_f32_16x16x32_bf16 v[96:99], v[8:11], a[124:127], v[96:99]
    s_mov_b64 exec, 1
    global_store_dword v2, v3, s[44:45] offset:0 sc1
    s_mov_b64 exec, -1
    s_nop 1
    v_cmp_ne_u32 vcc, 0, v229
    s_cmp_eq_u64 vcc, 0
    s_cselect_b32 s100, 1, 0
    v_and_b32 v97, 0xffff0000, v96
    v_sub_f32 v98, v96, v97
    v_and_b32 v99, 0xffff0000, v98
    v_sub_f32 v98, v98, v99
    v_lshrrev_b32 v97, 16, v97
    v_or_b32 v16, v97, v99
    v_lshrrev_b32 v17, 16, v98
    v_mov_b32 v18, 0
    v_mov_b32 v19, 0
    s_lshl_b32 s64, s49, 3
    s_lshl_b32 s65, s46, 2
    s_add_u32 s64, s64, s65
    s_add_u32 s64, s64, 45056
    v_mov_b32 v2, s64
    s_lshl_b32 s64, s50, 7
    s_add_u32 s64, s64, 45056
    v_add_u32_e64 v35, s64, v35
    s_waitcnt vmcnt(13)
    ds_read_b64_tr_b16 v[128:129], v244 offset:0
    ds_read_b64_tr_b16 v[130:131], v244 offset:1024
    ds_read_b64_tr_b16 v[132:133], v245 offset:0
    ds_read_b64_tr_b16 v[134:135], v245 offset:1024
    ds_read_b64_tr_b16 v[136:137], v244 offset:2048
    ds_read_b64_tr_b16 v[138:139], v244 offset:3072
    ds_read_b64_tr_b16 v[140:141], v245 offset:2048
    ds_read_b64_tr_b16 v[142:143], v245 offset:3072
    ds_read_b64_tr_b16 v[144:145], v244 offset:4096
    ds_read_b64_tr_b16 v[146:147], v244 offset:5120
    ds_read_b64_tr_b16 v[148:149], v245 offset:4096
    ds_read_b64_tr_b16 v[150:151], v245 offset:5120
    ds_read_b64_tr_b16 v[152:153], v244 offset:6144
    ds_read_b64_tr_b16 v[154:155], v244 offset:7168
    ds_read_b64_tr_b16 v[156:157], v245 offset:6144
    ds_read_b64_tr_b16 v[158:159], v245 offset:7168
    s_branch L_p2chk_12
L_p2retry_11:
    s_nop 0
    global_load_dwordx4 v[64:67], v232, s[44:45] sc1
    global_load_dwordx4 v[68:71], v233, s[44:45] sc1
    global_load_dwordx4 v[72:75], v234, s[44:45] sc1
    global_load_dwordx4 v[76:79], v235, s[44:45] sc1
    s_waitcnt vmcnt(0)
L_p2chk_12:
    s_lshl_b32 s64, s50, 7
    s_waitcnt vmcnt(1)
    v_bitop3_b32 v80, v64, v65, v3 bitop3:0x7e
    v_bitop3_b32 v81, v66, v67, v3 bitop3:0x7e
    s_nop 0
    v_bitop3_b32 v82, v68, v69, v3 bitop3:0x7e
    v_bitop3_b32 v83, v70, v71, v3 bitop3:0x7e
    v_bitop3_b32 v84, v72, v73, v3 bitop3:0x7e
    v_bitop3_b32 v85, v74, v75, v3 bitop3:0x7e
    v_bitop3_b32 v86, v76, v77, v3 bitop3:0x7e
    v_bitop3_b32 v87, v78, v79, v3 bitop3:0x7e
    v_or3_b32 v80, v80, v81, v82
    v_or3_b32 v83, v83, v84, v85
    v_or3_b32 v80, v80, v86, v87
    v_or_b32 v80, v80, v83
    v_cmp_ne_u32_e64 vcc, 0, v80
    s_cbranch_vccz L_spin_done_13
    s_add_u32 s8, s8, 1
    s_cmp_lt_u32 s8, 262144
    s_cbranch_scc1 L_p2retry_11
L_spin_done_13:
    s_mov_b32 m0, 0
    s_add_u32 s66, s64, 0
    buffer_load_dwordx4 v36, s[56:59], s66 offen offset:0 sc1 lds
    buffer_load_dwordx4 v37, s[56:59], s66 offen offset:1024 sc1 lds
    buffer_load_dwordx4 v38, s[56:59], s66 offen offset:2048 sc1 lds
    buffer_load_dwordx4 v39, s[56:59], s66 offen offset:3072 sc1 lds
    s_mov_b32 m0, 4096
    s_add_u32 s66, s64, 131072
    buffer_load_dwordx4 v36, s[56:59], s66 offen offset:0 sc1 lds
    buffer_load_dwordx4 v37, s[56:59], s66 offen offset:1024 sc1 lds
    buffer_load_dwordx4 v38, s[56:59], s66 offen offset:2048 sc1 lds
    buffer_load_dwordx4 v39, s[56:59], s66 offen offset:3072 sc1 lds
    s_mov_b32 m0, 8192
    s_add_u32 s66, s64, 262144
    buffer_load_dwordx4 v36, s[56:59], s66 offen offset:0 sc1 lds
    buffer_load_dwordx4 v37, s[56:59], s66 offen offset:1024 sc1 lds
    buffer_load_dwordx4 v38, s[56:59], s66 offen offset:2048 sc1 lds
    buffer_load_dwordx4 v39, s[56:59], s66 offen offset:3072 sc1 lds
    s_mov_b32 m0, 12288
    s_add_u32 s66, s64, 393216
    buffer_load_dwordx4 v36, s[56:59], s66 offen offset:0 sc1 lds
    buffer_load_dwordx4 v37, s[56:59], s66 offen offset:1024 sc1 lds
    buffer_load_dwordx4 v38, s[56:59], s66 offen offset:2048 sc1 lds
    buffer_load_dwordx4 v39, s[56:59], s66 offen offset:3072 sc1 lds
    s_mov_b32 m0, 16384
    s_add_u32 s66, s64, 524288
    buffer_load_dwordx4 v36, s[56:59], s66 offen offset:0 sc1 lds
    buffer_load_dwordx4 v37, s[56:59], s66 offen offset:1024 sc1 lds
    buffer_load_dwordx4 v38, s[56:59], s66 offen offset:2048 sc1 lds
    buffer_load_dwordx4 v39, s[56:59], s66 offen offset:3072 sc1 lds
    s_mov_b32 m0, 20480
    s_add_u32 s66, s64, 655360
    buffer_load_dwordx4 v36, s[56:59], s66 offen offset:0 sc1 lds
    buffer_load_dwordx4 v37, s[56:59], s66 offen offset:1024 sc1 lds
    buffer_load_dwordx4 v38, s[56:59], s66 offen offset:2048 sc1 lds
    buffer_load_dwordx4 v39, s[56:59], s66 offen offset:3072 sc1 lds
    s_mov_b32 m0, 24576
    s_add_u32 s66, s64, 786432
    buffer_load_dwordx4 v36, s[56:59], s66 offen offset:0 sc1 lds
    buffer_load_dwordx4 v37, s[56:59], s66 offen offset:1024 sc1 lds
    buffer_load_dwordx4 v38, s[56:59], s66 offen offset:2048 sc1 lds
    buffer_load_dwordx4 v39, s[56:59], s66 offen offset:3072 sc1 lds
    s_mov_b32 m0, 28672
    s_add_u32 s66, s64, 917504
    buffer_load_dwordx4 v36, s[56:59], s66 offen offset:0 sc1 lds
    buffer_load_dwordx4 v37, s[56:59], s66 offen offset:1024 sc1 lds
    buffer_load_dwordx4 v38, s[56:59], s66 offen offset:2048 sc1 lds
    buffer_load_dwordx4 v39, s[56:59], s66 offen offset:3072 sc1 lds
    s_mov_b32 m0, 32768
    s_add_u32 s66, s64, 1048576
    buffer_load_dwordx4 v36, s[56:59], s66 offen offset:0 sc1 lds
    buffer_load_dwordx4 v37, s[56:59], s66 offen offset:1024 sc1 lds
    buffer_load_dwordx4 v38, s[56:59], s66 offen offset:2048 sc1 lds
    buffer_load_dwordx4 v39, s[56:59], s66 offen offset:3072 sc1 lds
    s_mov_b32 m0, 36864
    s_add_u32 s66, s64, 1179648
    buffer_load_dwordx4 v36, s[56:59], s66 offen offset:0 sc1 lds
    buffer_load_dwordx4 v37, s[56:59], s66 offen offset:1024 sc1 lds
    buffer_load_dwordx4 v38, s[56:59], s66 offen offset:2048 sc1 lds
    buffer_load_dwordx4 v39, s[56:59], s66 offen offset:3072 sc1 lds
    s_cmp_eq_u32 s34, 0
    s_cbranch_scc1 L_skiptr_14
    ds_read_b64_tr_b16 v[160:161], v244 offset:8192
    ds_read_b64_tr_b16 v[162:163], v244 offset:9216
    ds_read_b64_tr_b16 v[164:165], v245 offset:8192
    ds_read_b64_tr_b16 v[166:167], v245 offset:9216
    ds_read_b64_tr_b16 v[168:169], v244 offset:10240
    ds_read_b64_tr_b16 v[170:171], v244 offset:11264
    ds_read_b64_tr_b16 v[172:173], v245 offset:10240
    ds_read_b64_tr_b16 v[174:175], v245 offset:11264
    ds_read_b64_tr_b16 v[176:177], v244 offset:12288
    ds_read_b64_tr_b16 v[178:179], v244 offset:13312
    ds_read_b64_tr_b16 v[180:181], v245 offset:12288
    ds_read_b64_tr_b16 v[182:183], v245 offset:13312
    ds_read_b64_tr_b16 v[184:185], v244 offset:14336
    ds_read_b64_tr_b16 v[186:187], v244 offset:15360
    ds_read_b64_tr_b16 v[188:189], v245 offset:14336
    ds_read_b64_tr_b16 v[190:191], v245 offset:15360
L_skiptr_14:
    s_waitcnt vmcnt(28)
    s_barrier
    ds_read_b64_tr_b16 v[40:41], v250 offset:0
    ds_read_b64_tr_b16 v[42:43], v250 offset:1024
    ds_read_b64_tr_b16 v[44:45], v251 offset:0
    ds_read_b64_tr_b16 v[46:47], v251 offset:1024
    ds_read_b64_tr_b16 v[48:49], v250 offset:2048
    ds_read_b64_tr_b16 v[50:51], v250 offset:3072
    ds_read_b64_tr_b16 v[52:53], v251 offset:2048
    ds_read_b64_tr_b16 v[54:55], v251 offset:3072
    ds_read_b64_tr_b16 v[56:57], v250 offset:4096
    ds_read_b64_tr_b16 v[58:59], v250 offset:5120
    ds_read_b64_tr_b16 v[60:61], v251 offset:4096
    ds_read_b64_tr_b16 v[62:63], v251 offset:5120
    ds_read_b64_tr_b16 v[80:81], v250 offset:6144
    ds_read_b64_tr_b16 v[82:83], v250 offset:7168
    ds_read_b64_tr_b16 v[84:85], v251 offset:6144
    ds_read_b64_tr_b16 v[86:87], v251 offset:7168
    s_waitcnt lgkmcnt(14)
    v_mfma_f32_32x32x16_bf16 v[64:79], a[0:3], v[40:43], 0
    ds_read_b64_tr_b16 v[88:89], v250 offset:8192
    ds_read_b64_tr_b16 v[90:91], v250 offset:9216
    ds_read_b64_tr_b16 v[92:93], v251 offset:8192
    ds_read_b64_tr_b16 v[94:95], v251 offset:9216
    s_waitcnt lgkmcnt(14)
    v_mfma_f32_16x16x32_bf16 v[12:15], v[8:11], v[40:43], 0
    v_mfma_f32_16x16x32_bf16 v[4:7], v[8:11], v[44:47], 0
    v_mfma_f32_32x32x16_bf16 v[64:79], a[4:7], v[48:51], v[64:79]
    ds_read_b64_tr_b16 v[112:113], v250 offset:10240
    ds_read_b64_tr_b16 v[114:115], v250 offset:11264
    ds_read_b64_tr_b16 v[116:117], v251 offset:10240
    ds_read_b64_tr_b16 v[118:119], v251 offset:11264
    s_waitcnt lgkmcnt(14)
    s_nop 0
    v_mfma_f32_16x16x32_bf16 v[12:15], v[8:11], v[48:51], v[12:15]
    v_mfma_f32_16x16x32_bf16 v[4:7], v[8:11], v[52:55], v[4:7]
    s_waitcnt vmcnt(12)
    s_barrier
    v_mfma_f32_32x32x16_bf16 v[64:79], a[8:11], v[56:59], v[64:79]
    ds_read_b64_tr_b16 v[40:41], v250 offset:12288
    ds_read_b64_tr_b16 v[42:43], v250 offset:13312
    ds_read_b64_tr_b16 v[44:45], v251 offset:12288
    ds_read_b64_tr_b16 v[46:47], v251 offset:13312
    s_waitcnt lgkmcnt(14)
    v_mfma_f32_16x16x32_bf16 v[12:15], v[8:11], v[56:59], v[12:15]
    v_mfma_f32_16x16x32_bf16 v[4:7], v[8:11], v[60:63], v[4:7]
    v_mfma_f32_32x32x16_bf16 v[64:79], a[12:15], v[80:83], v[64:79]
    ds_read_b64_tr_b16 v[48:49], v250 offset:14336
    ds_read_b64_tr_b16 v[50:51], v250 offset:15360
    ds_read_b64_tr_b16 v[52:53], v251 offset:14336
    ds_read_b64_tr_b16 v[54:55], v251 offset:15360
    s_waitcnt lgkmcnt(14)
    v_mfma_f32_16x16x32_bf16 v[12:15], v[8:11], v[80:83], v[12:15]
    v_mfma_f32_16x16x32_bf16 v[4:7], v[8:11], v[84:87], v[4:7]
    v_mfma_f32_32x32x16_bf16 v[64:79], a[16:19], v[88:91], v[64:79]
    ds_read_b64_tr_b16 v[56:57], v250 offset:16384
    ds_read_b64_tr_b16 v[58:59], v250 offset:17408
    ds_read_b64_tr_b16 v[60:61], v251 offset:16384
    ds_read_b64_tr_b16 v[62:63], v251 offset:17408
    s_waitcnt lgkmcnt(14)
    s_nop 0
    v_mfma_f32_16x16x32_bf16 v[12:15], v[8:11], v[88:91], v[12:15]
    v_mfma_f32_16x16x32_bf16 v[4:7], v[8:11], v[92:95], v[4:7]
    v_mfma_f32_32x32x16_bf16 v[64:79], a[20:23], v[112:115], v[64:79]
    ds_read_b64_tr_b16 v[80:81], v250 offset:18432
    ds_read_b64_tr_b16 v[82:83], v250 offset:19456
    ds_read_b64_tr_b16 v[84:85], v251 offset:18432
    ds_read_b64_tr_b16 v[86:87], v251 offset:19456
    s_waitcnt lgkmcnt(14)
    s_nop 0
    v_mfma_f32_16x16x32_bf16 v[12:15], v[8:11], v[112:115], v[12:15]
    v_mfma_f32_16x16x32_bf16 v[4:7], v[8:11], v[116:119], v[4:7]
    v_mfma_f32_32x32x16_bf16 v[64:79], a[24:27], v[40:43], v[64:79]
    ds_read_b64_tr_b16 v[88:89], v250 offset:20480
    ds_read_b64_tr_b16 v[90:91], v250 offset:21504
    ds_read_b64_tr_b16 v[92:93], v251 offset:20480
    ds_read_b64_tr_b16 v[94:95], v251 offset:21504
    s_waitcnt lgkmcnt(14)
    s_nop 0
    v_mfma_f32_16x16x32_bf16 v[12:15], v[8:11], v[40:43], v[12:15]
    v_mfma_f32_16x16x32_bf16 v[4:7], v[8:11], v[44:47], v[4:7]
    v_mfma_f32_32x32x16_bf16 v[64:79], a[28:31], v[48:51], v[64:79]
    ds_read_b64_tr_b16 v[112:113], v250 offset:22528
    ds_read_b64_tr_b16 v[114:115], v250 offset:23552
    ds_read_b64_tr_b16 v[116:117], v251 offset:22528
    ds_read_b64_tr_b16 v[118:119], v251 offset:23552
    s_waitcnt lgkmcnt(14)
    s_nop 0
    v_mfma_f32_16x16x32_bf16 v[12:15], v[8:11], v[48:51], v[12:15]
    v_mfma_f32_16x16x32_bf16 v[4:7], v[8:11], v[52:55], v[4:7]
    v_mfma_f32_32x32x16_bf16 v[64:79], a[32:35], v[56:59], v[64:79]
    ds_read_b64_tr_b16 v[40:41], v250 offset:24576
    ds_read_b64_tr_b16 v[42:43], v250 offset:25600
    ds_read_b64_tr_b16 v[44:45], v251 offset:24576
    ds_read_b64_tr_b16 v[46:47], v251 offset:25600
    s_waitcnt lgkmcnt(14)
    s_nop 0
    v_mfma_f32_16x16x32_bf16 v[12:15], v[8:11], v[56:59], v[12:15]
    v_mfma_f32_16x16x32_bf16 v[4:7], v[8:11], v[60:63], v[4:7]
    v_mfma_f32_32x32x16_bf16 v[64:79], a[36:39], v[80:83], v[64:79]
    ds_read_b64_tr_b16 v[48:49], v250 offset:26624
    ds_read_b64_tr_b16 v[50:51], v250 offset:27648
    ds_read_b64_tr_b16 v[52:53], v251 offset:26624
    ds_read_b64_tr_b16 v[54:55], v251 offset:27648
    s_waitcnt lgkmcnt(14)
    s_nop 0
    v_mfma_f32_16x16x32_bf16 v[12:15], v[8:11], v[80:83], v[12:15]
    v_mfma_f32_16x16x32_bf16 v[4:7], v[8:11], v[84:87], v[4:7]
    s_waitcnt vmcnt(0)
    s_barrier
    v_mfma_f32_32x32x16_bf16 v[64:79], a[40:43], v[88:91], v[64:79]
    ds_read_b64_tr_b16 v[56:57], v250 offset:28672
    ds_read_b64_tr_b16 v[58:59], v250 offset:29696
    ds_read_b64_tr_b16 v[60:61], v251 offset:28672
    ds_read_b64_tr_b16 v[62:63], v251 offset:29696
    s_waitcnt lgkmcnt(14)
    v_mfma_f32_16x16x32_bf16 v[12:15], v[8:11], v[88:91], v[12:15]
    v_mfma_f32_16x16x32_bf16 v[4:7], v[8:11], v[92:95], v[4:7]
    v_mfma_f32_32x32x16_bf16 v[64:79], a[44:47], v[112:115], v[64:79]
    ds_read_b64_tr_b16 v[80:81], v250 offset:30720
    ds_read_b64_tr_b16 v[82:83], v250 offset:31744
    ds_read_b64_tr_b16 v[84:85], v251 offset:30720
    ds_read_b64_tr_b16 v[86:87], v251 offset:31744
    s_waitcnt lgkmcnt(14)
    v_mfma_f32_16x16x32_bf16 v[12:15], v[8:11], v[112:115], v[12:15]
    v_mfma_f32_16x16x32_bf16 v[4:7], v[8:11], v[116:119], v[4:7]
    v_mfma_f32_32x32x16_bf16 v[64:79], a[48:51], v[40:43], v[64:79]
    ds_read_b64_tr_b16 v[88:89], v250 offset:32768
    ds_read_b64_tr_b16 v[90:91], v250 offset:33792
    ds_read_b64_tr_b16 v[92:93], v251 offset:32768
    ds_read_b64_tr_b16 v[94:95], v251 offset:33792
    s_waitcnt lgkmcnt(14)
    s_nop 0
    v_mfma_f32_16x16x32_bf16 v[12:15], v[8:11], v[40:43], v[12:15]
    v_mfma_f32_16x16x32_bf16 v[4:7], v[8:11], v[44:47], v[4:7]
    v_mfma_f32_32x32x16_bf16 v[64:79], a[52:55], v[48:51], v[64:79]
    ds_read_b64_tr_b16 v[112:113], v250 offset:34816
    ds_read_b64_tr_b16 v[114:115], v250 offset:35840
    ds_read_b64_tr_b16 v[116:117], v251 offset:34816
    ds_read_b64_tr_b16 v[118:119], v251 offset:35840
    s_waitcnt lgkmcnt(14)
    s_nop 0
    v_mfma_f32_16x16x32_bf16 v[12:15], v[8:11], v[48:51], v[12:15]
    v_mfma_f32_16x16x32_bf16 v[4:7], v[8:11], v[52:55], v[4:7]
    v_mfma_f32_32x32x16_bf16 v[64:79], a[56:59], v[56:59], v[64:79]
    ds_read_b64_tr_b16 v[40:41], v250 offset:36864
    ds_read_b64_tr_b16 v[42:43], v250 offset:37888
    ds_read_b64_tr_b16 v[44:45], v251 offset:36864
    ds_read_b64_tr_b16 v[46:47], v251 offset:37888
    s_waitcnt lgkmcnt(14)
    s_nop 0
    v_mfma_f32_16x16x32_bf16 v[12:15], v[8:11], v[56:59], v[12:15]
    v_mfma_f32_16x16x32_bf16 v[4:7], v[8:11], v[60:63], v[4:7]
    v_mfma_f32_32x32x16_bf16 v[64:79], a[60:63], v[80:83], v[64:79]
    ds_read_b64_tr_b16 v[48:49], v250 offset:38912
    ds_read_b64_tr_b16 v[50:51], v250 offset:39936
    ds_read_b64_tr_b16 v[52:53], v251 offset:38912
    ds_read_b64_tr_b16 v[54:55], v251 offset:39936
    s_waitcnt lgkmcnt(14)
    s_nop 0
    v_mfma_f32_16x16x32_bf16 v[12:15], v[8:11], v[80:83], v[12:15]
    v_mfma_f32_16x16x32_bf16 v[4:7], v[8:11], v[84:87], v[4:7]
    s_barrier
    v_mfma_f32_32x32x16_bf16 v[64:79], a[64:67], v[88:91], v[64:79]
    ds_read_b64_tr_b16 v[56:57], v250 offset:40960
    ds_read_b64_tr_b16 v[58:59], v250 offset:41984
    ds_read_b64_tr_b16 v[60:61], v251 offset:40960
    ds_read_b64_tr_b16 v[62:63], v251 offset:41984
    s_add_u32 m0, s60, 0
    s_lshl3_add_u32 s15, s20, s14
    buffer_load_dwordx4 v240, s[52:55], s15 offen offset:0  lds
    s_waitcnt lgkmcnt(14)
    v_mfma_f32_16x16x32_bf16 v[12:15], v[8:11], v[88:91], v[12:15]
    v_mfma_f32_16x16x32_bf16 v[4:7], v[8:11], v[92:95], v[4:7]
    v_mfma_f32_32x32x16_bf16 v[64:79], a[68:71], v[112:115], v[64:79]
    ds_read_b64_tr_b16 v[80:81], v250 offset:43008
    ds_read_b64_tr_b16 v[82:83], v250 offset:44032
    ds_read_b64_tr_b16 v[84:85], v251 offset:43008
    ds_read_b64_tr_b16 v[86:87], v251 offset:44032
    buffer_load_dwordx4 v241, s[52:55], s15 offen offset:1024  lds
    s_waitcnt lgkmcnt(14)
    v_mfma_f32_16x16x32_bf16 v[12:15], v[8:11], v[112:115], v[12:15]
    v_mfma_f32_16x16x32_bf16 v[4:7], v[8:11], v[116:119], v[4:7]
    v_mfma_f32_32x32x16_bf16 v[64:79], a[72:75], v[40:43], v[64:79]
    ds_read_b64_tr_b16 v[88:89], v250 offset:45056
    ds_read_b64_tr_b16 v[90:91], v250 offset:46080
    s_nop 0
    ds_read_b64_tr_b16 v[92:93], v251 offset:45056
    ds_read_b64_tr_b16 v[94:95], v251 offset:46080
    buffer_load_dwordx4 v242, s[52:55], s15 offen offset:2048  lds
    s_waitcnt lgkmcnt(14)
    v_mfma_f32_16x16x32_bf16 v[12:15], v[8:11], v[40:43], v[12:15]
    v_mfma_f32_16x16x32_bf16 v[4:7], v[8:11], v[44:47], v[4:7]
    v_mfma_f32_32x32x16_bf16 v[64:79], a[76:79], v[48:51], v[64:79]
    ds_read_b64_tr_b16 v[112:113], v250 offset:47104
    s_nop 0
    ds_read_b64_tr_b16 v[114:115], v250 offset:48128
    ds_read_b64_tr_b16 v[116:117], v251 offset:47104
    ds_read_b64_tr_b16 v[118:119], v251 offset:48128
    buffer_load_dwordx4 v243, s[52:55], s15 offen offset:3072  lds
    s_waitcnt lgkmcnt(14)
    v_mfma_f32_16x16x32_bf16 v[12:15], v[8:11], v[48:51], v[12:15]
    v_mfma_f32_16x16x32_bf16 v[4:7], v[8:11], v[52:55], v[4:7]
    v_mfma_f32_32x32x16_bf16 v[64:79], a[80:83], v[56:59], v[64:79]
    s_nop 0
    ds_read_b64_tr_b16 v[40:41], v250 offset:49152
    ds_read_b64_tr_b16 v[42:43], v250 offset:50176
    ds_read_b64_tr_b16 v[44:45], v251 offset:49152
    ds_read_b64_tr_b16 v[46:47], v251 offset:50176
    s_add_u32 m0, s60, 4096
    s_lshl3_add_u32 s15, s21, s14
    buffer_load_dwordx4 v240, s[52:55], s15 offen offset:0  lds
    s_waitcnt lgkmcnt(14)
    v_mfma_f32_16x16x32_bf16 v[12:15], v[8:11], v[56:59], v[12:15]
    v_mfma_f32_16x16x32_bf16 v[4:7], v[8:11], v[60:63], v[4:7]
    v_mfma_f32_32x32x16_bf16 v[64:79], a[84:87], v[80:83], v[64:79]
    ds_read_b64_tr_b16 v[48:49], v250 offset:51200
    ds_read_b64_tr_b16 v[50:51], v250 offset:52224
    ds_read_b64_tr_b16 v[52:53], v251 offset:51200
    ds_read_b64_tr_b16 v[54:55], v251 offset:52224
    buffer_load_dwordx4 v241, s[52:55], s15 offen offset:1024  lds
    s_waitcnt lgkmcnt(14)
    s_nop 0
    v_mfma_f32_16x16x32_bf16 v[12:15], v[8:11], v[80:83], v[12:15]
    v_mfma_f32_16x16x32_bf16 v[4:7], v[8:11], v[84:87], v[4:7]
    s_barrier
    v_mfma_f32_32x32x16_bf16 v[64:79], a[88:91], v[88:91], v[64:79]
    ds_read_b64_tr_b16 v[56:57], v250 offset:53248
    ds_read_b64_tr_b16 v[58:59], v250 offset:54272
    ds_read_b64_tr_b16 v[60:61], v251 offset:53248
    ds_read_b64_tr_b16 v[62:63], v251 offset:54272
    s_nop 0
    buffer_load_dwordx4 v242, s[52:55], s15 offen offset:2048  lds
    s_waitcnt lgkmcnt(14)
    v_mfma_f32_16x16x32_bf16 v[12:15], v[8:11], v[88:91], v[12:15]
    v_mfma_f32_16x16x32_bf16 v[4:7], v[8:11], v[92:95], v[4:7]
    v_mfma_f32_32x32x16_bf16 v[64:79], a[92:95], v[112:115], v[64:79]
    ds_read_b64_tr_b16 v[80:81], v250 offset:55296
    ds_read_b64_tr_b16 v[82:83], v250 offset:56320
    ds_read_b64_tr_b16 v[84:85], v251 offset:55296
    s_nop 0
    ds_read_b64_tr_b16 v[86:87], v251 offset:56320
    buffer_load_dwordx4 v243, s[52:55], s15 offen offset:3072  lds
    s_waitcnt lgkmcnt(14)
    v_mfma_f32_16x16x32_bf16 v[12:15], v[8:11], v[112:115], v[12:15]
    v_mfma_f32_16x16x32_bf16 v[4:7], v[8:11], v[116:119], v[4:7]
    v_mfma_f32_32x32x16_bf16 v[64:79], a[96:99], v[40:43], v[64:79]
    ds_read_b64_tr_b16 v[88:89], v250 offset:57344
    ds_read_b64_tr_b16 v[90:91], v250 offset:58368
    s_nop 0
    ds_read_b64_tr_b16 v[92:93], v251 offset:57344
    ds_read_b64_tr_b16 v[94:95], v251 offset:58368
    s_add_u32 m0, s60, 8192
    s_lshl3_add_u32 s15, s22, s14
    buffer_load_dwordx4 v240, s[52:55], s15 offen offset:0  lds
    s_waitcnt lgkmcnt(14)
    v_mfma_f32_16x16x32_bf16 v[12:15], v[8:11], v[40:43], v[12:15]
    v_mfma_f32_16x16x32_bf16 v[4:7], v[8:11], v[44:47], v[4:7]
    v_mfma_f32_32x32x16_bf16 v[64:79], a[100:103], v[48:51], v[64:79]
    ds_read_b64_tr_b16 v[112:113], v250 offset:59392
    ds_read_b64_tr_b16 v[114:115], v250 offset:60416
    ds_read_b64_tr_b16 v[116:117], v251 offset:59392
    ds_read_b64_tr_b16 v[118:119], v251 offset:60416
    buffer_load_dwordx4 v241, s[52:55], s15 offen offset:1024  lds
    s_waitcnt lgkmcnt(14)
    v_mfma_f32_16x16x32_bf16 v[12:15], v[8:11], v[48:51], v[12:15]
    v_mfma_f32_16x16x32_bf16 v[4:7], v[8:11], v[52:55], v[4:7]
    s_nop 0
    v_mfma_f32_32x32x16_bf16 v[64:79], a[104:107], v[56:59], v[64:79]
    ds_read_b64_tr_b16 v[40:41], v250 offset:61440
    ds_read_b64_tr_b16 v[42:43], v250 offset:62464
    ds_read_b64_tr_b16 v[44:45], v251 offset:61440
    ds_read_b64_tr_b16 v[46:47], v251 offset:62464
    buffer_load_dwordx4 v242, s[52:55], s15 offen offset:2048  lds
    s_waitcnt lgkmcnt(14)
    v_mfma_f32_16x16x32_bf16 v[12:15], v[8:11], v[56:59], v[12:15]
    s_nop 0
    v_mfma_f32_16x16x32_bf16 v[4:7], v[8:11], v[60:63], v[4:7]
    v_mfma_f32_32x32x16_bf16 v[64:79], a[108:111], v[80:83], v[64:79]
    ds_read_b64_tr_b16 v[48:49], v250 offset:63488
    ds_read_b64_tr_b16 v[50:51], v250 offset:64512
    ds_read_b64_tr_b16 v[52:53], v251 offset:63488
    ds_read_b64_tr_b16 v[54:55], v251 offset:64512
    buffer_load_dwordx4 v243, s[52:55], s15 offen offset:3072  lds
    s_waitcnt lgkmcnt(14)
    s_nop 0
    v_mfma_f32_16x16x32_bf16 v[12:15], v[8:11], v[80:83], v[12:15]
    v_mfma_f32_16x16x32_bf16 v[4:7], v[8:11], v[84:87], v[4:7]
    v_mfma_f32_32x32x16_bf16 v[64:79], a[112:115], v[88:91], v[64:79]
    ds_read_b64_tr_b16 v[56:57], v251 offset:0
    ds_read_b64_tr_b16 v[58:59], v251 offset:1024
    s_add_u32 m0, s60, 12288
    s_lshl3_add_u32 s15, s23, s14
    buffer_load_dwordx4 v240, s[52:55], s15 offen offset:0  lds
    s_waitcnt lgkmcnt(14)
    v_mfma_f32_16x16x32_bf16 v[12:15], v[8:11], v[88:91], v[12:15]
    v_mfma_f32_16x16x32_bf16 v[4:7], v[8:11], v[92:95], v[4:7]
    s_waitcnt lgkmcnt(12)
    v_mfma_f32_32x32x16_bf16 v[64:79], a[116:119], v[112:115], v[64:79]
    ds_read_b64_tr_b16 v[80:81], v251 offset:2048
    ds_read_b64_tr_b16 v[82:83], v251 offset:3072
    buffer_load_dwordx4 v241, s[52:55], s15 offen offset:1024  lds
    s_waitcnt lgkmcnt(12)
    v_mfma_f32_16x16x32_bf16 v[12:15], v[8:11], v[112:115], v[12:15]
    v_mfma_f32_16x16x32_bf16 v[4:7], v[8:11], v[116:119], v[4:7]
    s_waitcnt lgkmcnt(10)
    v_mfma_f32_32x32x16_bf16 v[64:79], a[120:123], v[40:43], v[64:79]
    ds_read_b64_tr_b16 v[88:89], v251 offset:4096
    ds_read_b64_tr_b16 v[90:91], v251 offset:5120
    buffer_load_dwordx4 v242, s[52:55], s15 offen offset:2048  lds
    s_waitcnt lgkmcnt(10)
    v_mfma_f32_16x16x32_bf16 v[12:15], v[8:11], v[40:43], v[12:15]
    v_mfma_f32_16x16x32_bf16 v[4:7], v[8:11], v[44:47], v[4:7]
    s_waitcnt lgkmcnt(8)
    v_mfma_f32_32x32x16_bf16 v[64:79], a[124:127], v[48:51], v[64:79]
    ds_read_b64_tr_b16 v[112:113], v251 offset:6144
    ds_read_b64_tr_b16 v[114:115], v251 offset:7168
    buffer_load_dwordx4 v243, s[52:55], s15 offen offset:3072  lds
    s_waitcnt lgkmcnt(8)
    v_mfma_f32_16x16x32_bf16 v[12:15], v[8:11], v[48:51], v[12:15]
    v_mfma_f32_16x16x32_bf16 v[4:7], v[8:11], v[52:55], v[4:7]
    s_waitcnt lgkmcnt(6)
    s_nop 0
    v_mfma_f32_32x32x16_bf16 v[96:111], a[0:3], v[56:59], 0
    ds_read_b64_tr_b16 v[40:41], v251 offset:8192
    ds_read_b64_tr_b16 v[42:43], v251 offset:9216
    s_waitcnt lgkmcnt(6)
    v_mfma_f32_32x32x16_bf16 v[96:111], a[4:7], v[80:83], v[96:111]
    ds_read_b64_tr_b16 v[48:49], v251 offset:10240
    ds_read_b64_tr_b16 v[50:51], v251 offset:11264
    s_waitcnt lgkmcnt(6)
    v_mfma_f32_32x32x16_bf16 v[96:111], a[8:11], v[88:91], v[96:111]
    ds_read_b64_tr_b16 v[56:57], v251 offset:12288
    ds_read_b64_tr_b16 v[58:59], v251 offset:13312
    v_mul_f32 v32, 0x3b000000, v12
    v_mul_f32 v33, 0x3b000000, v4
    s_mov_b64 exec, s[70:71]
    ds_write2_b32 v34, v32, v33 offset0:0 offset1:32
    s_mov_b64 exec, -1
    s_waitcnt lgkmcnt(0)
    s_barrier
    ds_read2_b32 v[32:33], v34 offset0:0 offset1:32
    v_mfma_f32_32x32x16_bf16 v[96:111], a[12:15], v[112:115], v[96:111]
    ds_read_b64_tr_b16 v[80:81], v251 offset:14336
    ds_read_b64_tr_b16 v[82:83], v251 offset:15360
    s_waitcnt vmcnt(8)
    ds_read_b64_tr_b16 v[192:193], v244 offset:0
    ds_read_b64_tr_b16 v[194:195], v244 offset:1024
    v_mfma_f32_32x32x16_bf16 v[96:111], a[16:19], v[40:43], v[96:111]
    ds_read_b64_tr_b16 v[88:89], v251 offset:16384
    s_nop 0
    ds_read_b64_tr_b16 v[90:91], v251 offset:17408
    ds_read_b64_tr_b16 v[196:197], v245 offset:0
    ds_read_b64_tr_b16 v[198:199], v245 offset:1024
    ds_read_b64_tr_b16 v[200:201], v244 offset:2048
    v_mfma_f32_32x32x16_bf16 v[96:111], a[20:23], v[48:51], v[96:111]
    ds_read_b64_tr_b16 v[112:113], v251 offset:18432
    ds_read_b64_tr_b16 v[114:115], v251 offset:19456
    ds_read_b64_tr_b16 v[202:203], v244 offset:3072
    ds_read_b64_tr_b16 v[204:205], v245 offset:2048
    ds_read_b64_tr_b16 v[206:207], v245 offset:3072
    v_mfma_f32_32x32x16_bf16 v[96:111], a[24:27], v[56:59], v[96:111]
    ds_read_b64_tr_b16 v[40:41], v251 offset:20480
    ds_read_b64_tr_b16 v[42:43], v251 offset:21504
    ds_read_b64_tr_b16 v[208:209], v244 offset:4096
    ds_read_b64_tr_b16 v[210:211], v244 offset:5120
    ds_read_b64_tr_b16 v[212:213], v245 offset:4096
    s_waitcnt lgkmcnt(14)
    v_cmp_u_f32 vcc, v32, v33
    s_and_b64 vcc, vcc, s[34:35]
    s_cbranch_scc1 L_g1r3_8
    v_cvt_pk_bf16_f32 v24, -v32, -v32
    v_cndmask_b32 v24, 0, v24, s[70:71]
    v_and_b32 v25, 0xffff, v24
    v_cvt_pk_bf16_f32 v28, -v33, -v33
    v_cndmask_b32 v28, 0, v28, s[70:71]
    v_and_b32 v29, 0xffff, v28
    v_mfma_f32_32x32x16_bf16 v[96:111], a[28:31], v[80:83], v[96:111]
    ds_read_b64_tr_b16 v[48:49], v251 offset:22528
    ds_read_b64_tr_b16 v[50:51], v251 offset:23552
    ds_read_b64_tr_b16 v[214:215], v245 offset:5120
    ds_read_b64_tr_b16 v[216:217], v244 offset:6144
    ds_read_b64_tr_b16 v[218:219], v244 offset:7168
    s_waitcnt lgkmcnt(14)
    v_mfma_f32_32x32x16_bf16 v[96:111], a[32:35], v[88:91], v[96:111]
    s_nop 0
    ds_read_b64_tr_b16 v[56:57], v251 offset:24576
    ds_read_b64_tr_b16 v[58:59], v251 offset:25600
    ds_read_b64_tr_b16 v[220:221], v245 offset:6144
    ds_read_b64_tr_b16 v[222:223], v245 offset:7168
    v_mfma_f32_32x32x16_bf16 v[64:79], v[16:19], v[24:27], v[64:79]
    v_mfma_f32_32x32x16_bf16 v[96:111], v[16:19], v[28:31], v[96:111]
    s_waitcnt lgkmcnt(14)
    v_mfma_f32_32x32x16_bf16 v[96:111], a[36:39], v[112:115], v[96:111]
    s_nop 0
    ds_read_b64_tr_b16 v[80:81], v251 offset:26624
    ds_read_b64_tr_b16 v[82:83], v251 offset:27648
    s_waitcnt lgkmcnt(14)
    v_mfma_f32_32x32x16_bf16 v[96:111], a[40:43], v[40:43], v[96:111]
    ds_read_b64_tr_b16 v[88:89], v251 offset:28672
    ds_read_b64_tr_b16 v[90:91], v251 offset:29696
    s_barrier
    s_waitcnt lgkmcnt(11)
    v_mfma_f32_32x32x16_bf16 v[96:111], a[44:47], v[48:51], v[96:111]
    s_nop 0
    ds_read_b64_tr_b16 v[112:113], v251 offset:30720
    ds_read_b64_tr_b16 v[114:115], v251 offset:31744
    s_waitcnt vmcnt(0)
    ds_read_b64_tr_b16 a[0:1], v244 offset:8192
    ds_read_b64_tr_b16 a[2:3], v244 offset:9216
    s_waitcnt lgkmcnt(10)
    v_mfma_f32_32x32x16_bf16 v[96:111], a[48:51], v[56:59], v[96:111]
    ds_read_b64_tr_b16 v[40:41], v251 offset:32768
    ds_read_b64_tr_b16 v[42:43], v251 offset:33792
    ds_read_b64_tr_b16 a[128:129], v245 offset:8192
    ds_read_b64_tr_b16 a[130:131], v245 offset:9216
    ds_read_b64_tr_b16 a[4:5], v244 offset:10240
    s_waitcnt lgkmcnt(11)
    v_mfma_f32_32x32x16_bf16 v[96:111], a[52:55], v[80:83], v[96:111]
    ds_read_b64_tr_b16 v[48:49], v251 offset:34816
    ds_read_b64_tr_b16 v[50:51], v251 offset:35840
    ds_read_b64_tr_b16 a[6:7], v244 offset:11264
    s_nop 0
    ds_read_b64_tr_b16 a[132:133], v245 offset:10240
    ds_read_b64_tr_b16 a[134:135], v245 offset:11264
    s_waitcnt lgkmcnt(14)
    v_mfma_f32_32x32x16_bf16 v[96:111], a[56:59], v[88:91], v[96:111]
    ds_read_b64_tr_b16 v[56:57], v251 offset:36864
    ds_read_b64_tr_b16 v[58:59], v251 offset:37888
    v_cvt_pk_bf16_f32 v64, v64, v65
    v_cvt_pk_bf16_f32 v65, v66, v67
    s_nop 0
    v_cvt_pk_bf16_f32 v66, v68, v69
    s_waitcnt lgkmcnt(14)
    v_mfma_f32_32x32x16_bf16 v[96:111], a[60:63], v[112:115], v[96:111]
    ds_read_b64_tr_b16 v[80:81], v251 offset:38912
    ds_read_b64_tr_b16 v[82:83], v251 offset:39936
    v_cvt_pk_bf16_f32 v67, v70, v71
    v_pk_max_i16 v64, v64, 0
    v_pk_max_i16 v65, v65, 0
    s_waitcnt lgkmcnt(12)
    v_mfma_f32_32x32x16_bf16 v[96:111], a[64:67], v[40:43], v[96:111]
    ds_read_b64_tr_b16 v[88:89], v251 offset:40960
    ds_read_b64_tr_b16 v[90:91], v251 offset:41984
    v_pk_max_i16 v66, v66, 0
    v_pk_max_i16 v67, v67, 0
    s_cmp_eq_u32 s100, 0
    s_cbranch_scc1 L_stg_15
    global_store_dwordx4 v236, v[64:67], s[44:45] offset:-4096 nt
L_stb_16:
    s_waitcnt lgkmcnt(9)
    s_nop 0
    v_mfma_f32_32x32x16_bf16 v[96:111], a[68:71], v[48:51], v[96:111]
    ds_read_b64_tr_b16 v[112:113], v251 offset:43008
    ds_read_b64_tr_b16 v[114:115], v251 offset:44032
    v_cvt_pk_bf16_f32 v68, v72, v73
    v_cvt_pk_bf16_f32 v69, v74, v75
    v_cvt_pk_bf16_f32 v70, v76, v77
    s_waitcnt lgkmcnt(6)
    v_mfma_f32_32x32x16_bf16 v[96:111], a[72:75], v[56:59], v[96:111]
    s_nop 0
    ds_read_b64_tr_b16 v[40:41], v251 offset:45056
    ds_read_b64_tr_b16 v[42:43], v251 offset:46080
    v_cvt_pk_bf16_f32 v71, v78, v79
    v_pk_max_i16 v68, v68, 0
    v_pk_max_i16 v69, v69, 0
    s_waitcnt lgkmcnt(6)
    v_mfma_f32_32x32x16_bf16 v[96:111], a[76:79], v[80:83], v[96:111]
    ds_read_b64_tr_b16 v[48:49], v251 offset:47104
    s_nop 0
    ds_read_b64_tr_b16 v[50:51], v251 offset:48128
    v_pk_max_i16 v70, v70, 0
    v_pk_max_i16 v71, v71, 0
    s_cmp_eq_u32 s100, 0
    s_cbranch_scc1 L_stg_17
    global_store_dwordx4 v236, v[68:71], s[44:45] offset:-2048 nt
L_stb_18:
    s_waitcnt lgkmcnt(6)
    v_mfma_f32_32x32x16_bf16 v[96:111], a[80:83], v[88:91], v[96:111]
    ds_read_b64_tr_b16 v[56:57], v251 offset:49152
    s_nop 0
    ds_read_b64_tr_b16 v[58:59], v251 offset:50176
    ds_read_b64_tr_b16 a[8:9], v244 offset:12288
    ds_read_b64_tr_b16 a[10:11], v244 offset:13312
    ds_read_b64_tr_b16 a[136:137], v245 offset:12288
    s_waitcnt lgkmcnt(9)
    v_mfma_f32_32x32x16_bf16 v[96:111], a[84:87], v[112:115], v[96:111]
    ds_read_b64_tr_b16 v[80:81], v251 offset:51200
    ds_read_b64_tr_b16 v[82:83], v251 offset:52224
    s_nop 0
    ds_read_b64_tr_b16 a[138:139], v245 offset:13312
    ds_read_b64_tr_b16 a[12:13], v244 offset:14336
    ds_read_b64_tr_b16 a[14:15], v244 offset:15360
    s_waitcnt lgkmcnt(12)
    v_mfma_f32_32x32x16_bf16 v[96:111], a[88:91], v[40:43], v[96:111]
    ds_read_b64_tr_b16 v[88:89], v251 offset:53248
    ds_read_b64_tr_b16 v[90:91], v251 offset:54272
    ds_read_b64_tr_b16 a[140:141], v245 offset:14336
    s_nop 0
    ds_read_b64_tr_b16 a[142:143], v245 offset:15360
    s_waitcnt lgkmcnt(14)
    v_mfma_f32_32x32x16_bf16 v[96:111], a[92:95], v[48:51], v[96:111]
    ds_read_b64_tr_b16 v[112:113], v251 offset:55296
    ds_read_b64_tr_b16 v[114:115], v251 offset:56320
    s_waitcnt lgkmcnt(14)
    v_mfma_f32_32x32x16_bf16 v[96:111], a[96:99], v[56:59], v[96:111]
    ds_read_b64_tr_b16 v[40:41], v251 offset:57344
    ds_read_b64_tr_b16 v[42:43], v251 offset:58368
    s_waitcnt lgkmcnt(11)
    v_mfma_f32_32x32x16_bf16 v[96:111], a[100:103], v[80:83], v[96:111]
    ds_read_b64_tr_b16 v[48:49], v251 offset:59392
    ds_read_b64_tr_b16 v[50:51], v251 offset:60416
    s_waitcnt lgkmcnt(8)
    v_mfma_f32_32x32x16_bf16 v[96:111], a[104:107], v[88:91], v[96:111]
    ds_read_b64_tr_b16 v[56:57], v251 offset:61440
    ds_read_b64_tr_b16 v[58:59], v251 offset:62464
    s_waitcnt lgkmcnt(6)
    s_nop 0
    v_mfma_f32_32x32x16_bf16 v[96:111], a[108:111], v[112:115], v[96:111]
    ds_read_b64_tr_b16 v[80:81], v251 offset:63488
    ds_read_b64_tr_b16 v[82:83], v251 offset:64512
    s_waitcnt lgkmcnt(6)
    v_mfma_f32_32x32x16_bf16 v[96:111], a[112:115], v[40:43], v[96:111]
    s_waitcnt lgkmcnt(4)
    v_mfma_f32_32x32x16_bf16 v[96:111], a[116:119], v[48:51], v[96:111]
    s_waitcnt lgkmcnt(2)
    v_mfma_f32_32x32x16_bf16 v[96:111], a[120:123], v[56:59], v[96:111]
    s_waitcnt lgkmcnt(0)
    v_mfma_f32_32x32x16_bf16 v[96:111], a[124:127], v[80:83], v[96:111]
    s_waitcnt vmcnt(0)
    s_cmp_eq_u32 s100, 0
    s_mov_b64 exec, 1
    s_cbranch_scc1 L_stg_19
    global_store_dword v2, v3, s[44:45]
L_stb_20:
    s_mov_b64 exec, -1
    s_nop 5
    v_cvt_pk_bf16_f32 v96, v96, v97
    v_cvt_pk_bf16_f32 v97, v98, v99
    v_cvt_pk_bf16_f32 v98, v100, v101
    v_cvt_pk_bf16_f32 v99, v102, v103
    v_pk_max_i16 v96, v96, 0
    v_pk_max_i16 v97, v97, 0
    v_pk_max_i16 v98, v98, 0
    v_pk_max_i16 v99, v99, 0
    s_cmp_eq_u32 s100, 0
    s_cbranch_scc1 L_stg_21
    global_store_dwordx4 v236, v[96:99], s[44:45] offset:-3072 nt
L_stb_22:
    v_cvt_pk_bf16_f32 v100, v104, v105
    v_cvt_pk_bf16_f32 v101, v106, v107
    v_cvt_pk_bf16_f32 v102, v108, v109
    v_cvt_pk_bf16_f32 v103, v110, v111
    v_pk_max_i16 v100, v100, 0
    v_pk_max_i16 v101, v101, 0
    v_pk_max_i16 v102, v102, 0
    v_pk_max_i16 v103, v103, 0
    s_cmp_eq_u32 s100, 0
    s_cbranch_scc1 L_stg_23
    global_store_dwordx4 v236, v[100:103], s[44:45] offset:-1024 nt
L_stb_24:
    s_add_u32 m0, s60, 8192
    s_lshl3_add_u32 s15, s24, s14
    buffer_load_dwordx4 v240, s[52:55], s15 offen offset:0  lds
    buffer_load_dwordx4 v241, s[52:55], s15 offen offset:1024  lds
    buffer_load_dwordx4 v242, s[52:55], s15 offen offset:2048  lds
    buffer_load_dwordx4 v243, s[52:55], s15 offen offset:3072  lds
    s_add_u32 m0, s60, 12288
    s_lshl3_add_u32 s15, s25, s14
    buffer_load_dwordx4 v240, s[52:55], s15 offen offset:0  lds
    buffer_load_dwordx4 v241, s[52:55], s15 offen offset:1024  lds
    buffer_load_dwordx4 v242, s[52:55], s15 offen offset:2048  lds
    buffer_load_dwordx4 v243, s[52:55], s15 offen offset:3072  lds
    s_add_u32 m0, s61, 0
    s_lshl3_add_u32 s15, s26, s14
    buffer_load_dwordx4 v240, s[52:55], s15 offen offset:0  lds
    buffer_load_dwordx4 v241, s[52:55], s15 offen offset:1024  lds
    buffer_load_dwordx4 v242, s[52:55], s15 offen offset:2048  lds
    buffer_load_dwordx4 v243, s[52:55], s15 offen offset:3072  lds
    s_add_u32 m0, s61, 4096
    s_lshl3_add_u32 s15, s27, s14
    buffer_load_dwordx4 v240, s[52:55], s15 offen offset:0  lds
    buffer_load_dwordx4 v241, s[52:55], s15 offen offset:1024  lds
    buffer_load_dwordx4 v242, s[52:55], s15 offen offset:2048  lds
    buffer_load_dwordx4 v243, s[52:55], s15 offen offset:3072  lds
    global_load_dword v238, v35, s[44:45] sc1
    s_waitcnt vmcnt(9)
    ds_read_b64_tr_b16 a[16:17], v244 offset:8192
    ds_read_b64_tr_b16 a[18:19], v244 offset:9216
    ds_read_b64_tr_b16 a[144:145], v245 offset:8192
    ds_read_b64_tr_b16 a[146:147], v245 offset:9216
    ds_read_b64_tr_b16 a[20:21], v244 offset:10240
    ds_read_b64_tr_b16 a[22:23], v244 offset:11264
    ds_read_b64_tr_b16 a[148:149], v245 offset:10240
    ds_read_b64_tr_b16 a[150:151], v245 offset:11264
    ds_read_b64_tr_b16 a[24:25], v244 offset:12288
    ds_read_b64_tr_b16 a[26:27], v244 offset:13312
    ds_read_b64_tr_b16 a[152:153], v245 offset:12288
    ds_read_b64_tr_b16 a[154:155], v245 offset:13312
    ds_read_b64_tr_b16 a[28:29], v244 offset:14336
    ds_read_b64_tr_b16 a[30:31], v244 offset:15360
    ds_read_b64_tr_b16 a[156:157], v245 offset:14336
    ds_read_b64_tr_b16 a[158:159], v245 offset:15360
    s_waitcnt vmcnt(0)
    s_branch L_g1j_5
L_w012_10:
    s_add_u32 m0, s61, 4096
    s_add_u32 s15, s14, 1720320
    buffer_load_dwordx4 v240, s[52:55], s15 offen offset:0  lds
    buffer_load_dwordx4 v241, s[52:55], s15 offen offset:1024  lds
    buffer_load_dwordx4 v242, s[52:55], s15 offen offset:2048  lds
    buffer_load_dwordx4 v243, s[52:55], s15 offen offset:3072  lds
    s_waitcnt vmcnt(19)
    s_nop 0
    ds_read_b64_tr_b16 a[80:81], v244 offset:0
    ds_read_b64_tr_b16 a[82:83], v244 offset:1024
    ds_read_b64_tr_b16 a[208:209], v245 offset:0
    ds_read_b64_tr_b16 a[210:211], v245 offset:1024
    ds_read_b64_tr_b16 a[84:85], v244 offset:2048
    ds_read_b64_tr_b16 a[86:87], v244 offset:3072
    ds_read_b64_tr_b16 a[212:213], v245 offset:2048
    ds_read_b64_tr_b16 a[214:215], v245 offset:3072
    ds_read_b64_tr_b16 a[88:89], v244 offset:4096
    ds_read_b64_tr_b16 a[90:91], v244 offset:5120
    ds_read_b64_tr_b16 a[216:217], v245 offset:4096
    ds_read_b64_tr_b16 a[218:219], v245 offset:5120
    ds_read_b64_tr_b16 a[92:93], v244 offset:6144
    ds_read_b64_tr_b16 a[94:95], v244 offset:7168
    ds_read_b64_tr_b16 a[220:221], v245 offset:6144
    ds_read_b64_tr_b16 a[222:223], v245 offset:7168
    s_waitcnt vmcnt(11)
    ds_read_b64_tr_b16 a[96:97], v244 offset:8192
    ds_read_b64_tr_b16 a[98:99], v244 offset:9216
    ds_read_b64_tr_b16 a[224:225], v245 offset:8192
    ds_read_b64_tr_b16 a[226:227], v245 offset:9216
    ds_read_b64_tr_b16 a[100:101], v244 offset:10240
    ds_read_b64_tr_b16 a[102:103], v244 offset:11264
    ds_read_b64_tr_b16 a[228:229], v245 offset:10240
    s_nop 0
    ds_read_b64_tr_b16 a[230:231], v245 offset:11264
    ds_read_b64_tr_b16 a[104:105], v244 offset:12288
    ds_read_b64_tr_b16 a[106:107], v244 offset:13312
    ds_read_b64_tr_b16 a[232:233], v245 offset:12288
    ds_read_b64_tr_b16 a[234:235], v245 offset:13312
    ds_read_b64_tr_b16 a[108:109], v244 offset:14336
    ds_read_b64_tr_b16 a[110:111], v244 offset:15360
    ds_read_b64_tr_b16 a[236:237], v245 offset:14336
    ds_read_b64_tr_b16 a[238:239], v245 offset:15360
    s_mov_b32 s52, s38
    s_mov_b32 s53, s39
    s_lshl_b32 s14, s51, 7
    s_mul_i32 s64, s51, 28672
    s_lshl_b32 s65, s3, 12
    s_add_u32 s16, s64, s65
    s_add_u32 s17, s16, 4096
    s_add_u32 s65, s64, 225280
    s_sub_u32 s66, s65, 229376
    s_min_u32 s65, s65, s66
    s_cmp_eq_u32 s46, 3
    s_cselect_b32 s17, s65, s17
    s_mul_i32 s65, s46, 49152
    s_add_u32 s64, s64, s65
    s_add_u32 s65, s64, 28672
    s_sub_u32 s66, s65, 229376
    s_min_u32 s18, s65, s66
    s_add_u32 s65, s64, 32768
    s_sub_u32 s66, s65, 229376
    s_min_u32 s19, s65, s66
    s_nop 0
    s_add_u32 s65, s64, 36864
    s_sub_u32 s66, s65, 229376
    s_min_u32 s20, s65, s66
    s_add_u32 s65, s64, 40960
    s_sub_u32 s66, s65, 229376
    s_min_u32 s21, s65, s66
    s_add_u32 s65, s64, 45056
    s_sub_u32 s66, s65, 229376
    s_min_u32 s22, s65, s66
    s_nop 0
    s_add_u32 s65, s64, 49152
    s_sub_u32 s66, s65, 229376
    s_min_u32 s23, s65, s66
    s_add_u32 s65, s64, 53248
    s_sub_u32 s66, s65, 229376
    s_min_u32 s24, s65, s66
    s_add_u32 s65, s64, 57344
    s_sub_u32 s66, s65, 229376
    s_min_u32 s25, s65, s66
    s_nop 0
    s_add_u32 s65, s64, 61440
    s_sub_u32 s66, s65, 229376
    s_min_u32 s26, s65, s66
    s_add_u32 s65, s64, 65536
    s_sub_u32 s66, s65, 229376
    s_min_u32 s27, s65, s66
    s_add_u32 s65, s64, 69632
    s_sub_u32 s66, s65, 229376
    s_min_u32 s28, s65, s66
    s_nop 0
    s_add_u32 s65, s64, 73728
    s_sub_u32 s66, s65, 229376
    s_min_u32 s29, s65, s66
    v_lshl_add_u32 v240, v248, 10, v249
    v_add_u32 v241, 7168, v240
    v_add_u32 v242, 14336, v240
    v_add_u32 v243, 21504, v240
    s_waitcnt lgkmcnt(0)
    v_mfma_f32_16x16x32_bf16 v[96:99], v[8:11], a[0:3], 0
    s_add_u32 m0, s60, 0
    s_lshl3_add_u32 s15, s16, s14
    buffer_load_dwordx4 v240, s[52:55], s15 offen offset:0  lds
    v_mfma_f32_16x16x32_bf16 v[100:103], v[8:11], a[128:131], 0
    v_mfma_f32_16x16x32_bf16 v[96:99], v[8:11], a[4:7], v[96:99]
    v_mfma_f32_16x16x32_bf16 v[100:103], v[8:11], a[132:135], v[100:103]
    buffer_load_dwordx4 v241, s[52:55], s15 offen offset:1024  lds
    v_mfma_f32_16x16x32_bf16 v[96:99], v[8:11], a[8:11], v[96:99]
    v_mfma_f32_16x16x32_bf16 v[100:103], v[8:11], a[136:139], v[100:103]
    v_mfma_f32_16x16x32_bf16 v[96:99], v[8:11], a[12:15], v[96:99]
    buffer_load_dwordx4 v242, s[52:55], s15 offen offset:2048  lds
    v_mfma_f32_16x16x32_bf16 v[100:103], v[8:11], a[140:143], v[100:103]
    v_mfma_f32_16x16x32_bf16 v[96:99], v[8:11], a[16:19], v[96:99]
    v_mfma_f32_16x16x32_bf16 v[100:103], v[8:11], a[144:147], v[100:103]
    buffer_load_dwordx4 v243, s[52:55], s15 offen offset:3072  lds
    v_mfma_f32_16x16x32_bf16 v[96:99], v[8:11], a[20:23], v[96:99]
    v_mfma_f32_16x16x32_bf16 v[100:103], v[8:11], a[148:151], v[100:103]
    v_mfma_f32_16x16x32_bf16 v[96:99], v[8:11], a[24:27], v[96:99]
    s_add_u32 m0, s60, 4096
    s_lshl3_add_u32 s15, s17, s14
    buffer_load_dwordx4 v240, s[52:55], s15 offen offset:0  lds
    v_mfma_f32_16x16x32_bf16 v[100:103], v[8:11], a[152:155], v[100:103]
    v_mfma_f32_16x16x32_bf16 v[96:99], v[8:11], a[28:31], v[96:99]
    v_mfma_f32_16x16x32_bf16 v[100:103], v[8:11], a[156:159], v[100:103]
    buffer_load_dwordx4 v241, s[52:55], s15 offen offset:1024  lds
    s_nop 0
    v_mfma_f32_16x16x32_bf16 v[96:99], v[8:11], a[32:35], v[96:99]
    v_mfma_f32_16x16x32_bf16 v[100:103], v[8:11], a[160:163], v[100:103]
    v_mfma_f32_16x16x32_bf16 v[96:99], v[8:11], a[36:39], v[96:99]
    buffer_load_dwordx4 v242, s[52:55], s15 offen offset:2048  lds
    v_mfma_f32_16x16x32_bf16 v[100:103], v[8:11], a[164:167], v[100:103]
    v_mfma_f32_16x16x32_bf16 v[96:99], v[8:11], a[40:43], v[96:99]
    v_mfma_f32_16x16x32_bf16 v[100:103], v[8:11], a[168:171], v[100:103]
    buffer_load_dwordx4 v243, s[52:55], s15 offen offset:3072  lds
    v_mfma_f32_16x16x32_bf16 v[96:99], v[8:11], a[44:47], v[96:99]
    v_mfma_f32_16x16x32_bf16 v[100:103], v[8:11], a[172:175], v[100:103]
    v_mfma_f32_16x16x32_bf16 v[96:99], v[8:11], a[48:51], v[96:99]
    s_add_u32 m0, s60, 8192
    s_lshl3_add_u32 s15, s18, s14
    buffer_load_dwordx4 v240, s[52:55], s15 offen offset:0  lds
    v_mfma_f32_16x16x32_bf16 v[100:103], v[8:11], a[176:179], v[100:103]
    v_mfma_f32_16x16x32_bf16 v[96:99], v[8:11], a[52:55], v[96:99]
    s_nop 0
    v_mfma_f32_16x16x32_bf16 v[100:103], v[8:11], a[180:183], v[100:103]
    buffer_load_dwordx4 v241, s[52:55], s15 offen offset:1024  lds
    v_mfma_f32_16x16x32_bf16 v[96:99], v[8:11], a[56:59], v[96:99]
    v_mfma_f32_16x16x32_bf16 v[100:103], v[8:11], a[184:187], v[100:103]
    v_mfma_f32_16x16x32_bf16 v[96:99], v[8:11], a[60:63], v[96:99]
    buffer_load_dwordx4 v242, s[52:55], s15 offen offset:2048  lds
    v_mfma_f32_16x16x32_bf16 v[100:103], v[8:11], a[188:191], v[100:103]
    v_mfma_f32_16x16x32_bf16 v[96:99], v[8:11], a[64:67], v[96:99]
    v_mfma_f32_16x16x32_bf16 v[100:103], v[8:11], a[192:195], v[100:103]
    buffer_load_dwordx4 v243, s[52:55], s15 offen offset:3072  lds
    v_mfma_f32_16x16x32_bf16 v[96:99], v[8:11], a[68:71], v[96:99]
    v_mfma_f32_16x16x32_bf16 v[100:103], v[8:11], a[196:199], v[100:103]
    v_mfma_f32_16x16x32_bf16 v[96:99], v[8:11], a[72:75], v[96:99]
    s_add_u32 m0, s60, 12288
    s_lshl3_add_u32 s15, s19, s14
    buffer_load_dwordx4 v240, s[52:55], s15 offen offset:0  lds
    s_nop 0
    v_mfma_f32_16x16x32_bf16 v[100:103], v[8:11], a[200:203], v[100:103]
    v_mfma_f32_16x16x32_bf16 v[96:99], v[8:11], a[76:79], v[96:99]
    v_mfma_f32_16x16x32_bf16 v[100:103], v[8:11], a[204:207], v[100:103]
    buffer_load_dwordx4 v241, s[52:55], s15 offen offset:1024  lds
    v_mfma_f32_16x16x32_bf16 v[96:99], v[8:11], a[80:83], v[96:99]
    v_mfma_f32_16x16x32_bf16 v[100:103], v[8:11], a[208:211], v[100:103]
    v_mfma_f32_16x16x32_bf16 v[96:99], v[8:11], a[84:87], v[96:99]
    buffer_load_dwordx4 v242, s[52:55], s15 offen offset:2048  lds
    v_mfma_f32_16x16x32_bf16 v[100:103], v[8:11], a[212:215], v[100:103]
    v_mfma_f32_16x16x32_bf16 v[96:99], v[8:11], a[88:91], v[96:99]
    v_mfma_f32_16x16x32_bf16 v[100:103], v[8:11], a[216:219], v[100:103]
    buffer_load_dwordx4 v243, s[52:55], s15 offen offset:3072  lds
    v_mfma_f32_16x16x32_bf16 v[96:99], v[8:11], a[92:95], v[96:99]
    v_mfma_f32_16x16x32_bf16 v[100:103], v[8:11], a[220:223], v[100:103]
    v_mfma_f32_16x16x32_bf16 v[96:99], v[8:11], a[96:99], v[96:99]
    v_mfma_f32_16x16x32_bf16 v[100:103], v[8:11], a[224:227], v[100:103]
    v_mfma_f32_16x16x32_bf16 v[96:99], v[8:11], a[100:103], v[96:99]
    v_mfma_f32_16x16x32_bf16 v[100:103], v[8:11], a[228:231], v[100:103]
    v_mfma_f32_16x16x32_bf16 v[96:99], v[8:11], a[104:107], v[96:99]
    v_mfma_f32_16x16x32_bf16 v[100:103], v[8:11], a[232:235], v[100:103]
    v_mfma_f32_16x16x32_bf16 v[96:99], v[8:11], a[108:111], v[96:99]
    v_mfma_f32_16x16x32_bf16 v[100:103], v[8:11], a[236:239], v[100:103]
    s_waitcnt vmcnt(16)
    ds_read_b64_tr_b16 a[112:113], v246 offset:0
    s_nop 0
    ds_read_b64_tr_b16 a[114:115], v246 offset:1024
    ds_read_b64_tr_b16 a[240:241], v247 offset:0
    ds_read_b64_tr_b16 a[242:243], v247 offset:1024
    ds_read_b64_tr_b16 a[116:117], v246 offset:2048
    ds_read_b64_tr_b16 a[118:119], v246 offset:3072
    ds_read_b64_tr_b16 a[244:245], v247 offset:2048
    ds_read_b64_tr_b16 a[246:247], v247 offset:3072
    ds_read_b64_tr_b16 a[120:121], v246 offset:4096
    ds_read_b64_tr_b16 a[122:123], v246 offset:5120
    ds_read_b64_tr_b16 a[248:249], v247 offset:4096
    ds_read_b64_tr_b16 a[250:251], v247 offset:5120
    ds_read_b64_tr_b16 a[124:125], v246 offset:6144
    ds_read_b64_tr_b16 a[126:127], v246 offset:7168
    ds_read_b64_tr_b16 a[252:253], v247 offset:6144
    ds_read_b64_tr_b16 a[254:255], v247 offset:7168
    s_lshl_b32 s64, s46, 5
    v_xor_b32 v244, s64, v250
    v_add_u32 v246, s61, v244
    v_add_u32 v244, s60, v244
    v_xor_b32 v245, s64, v251
    v_add_u32 v247, s61, v245
    v_add_u32 v245, s60, v245
    v_lshl_add_u32 v36, v248, 12, v249
    v_add_u32 v37, 31744, v36
    v_add_u32 v38, 63488, v36
    v_add_u32 v39, 95232, v36
    s_lshl_b32 s68, s46, 12
    s_lshl_b32 s69, s46, 17
    s_lshl_b32 s64, s50, 7
    s_add_u32 s69, s69, s64
    v_and_b32 v35, 31, v0
    v_lshlrev_b32 v35, 2, v35
    v_add_u32 v34, 90112, v35
    s_mul_i32 s64, s50, 229376
    s_add_u32 s64, s64, 4194304
    s_add_u32 s65, s64, s16
    s_add_u32 s65, s65, 4096
    v_add_u32_e64 v236, s65, v252
    s_add_u32 s36, s44, s64
    s_addc_u32 s37, s45, 0
    s_mov_b32 s38, 229376
    s_mov_b32 s39, 0x20000
    v_mov_b32 v26, 0
    v_mov_b32 v27, 0
    v_mov_b32 v30, 0
    v_mov_b32 v31, 0
    v_add_u32 v237, 1, v3
    s_waitcnt lgkmcnt(0)
    v_mfma_f32_16x16x32_bf16 v[96:99], v[8:11], a[112:115], v[96:99]
    v_mfma_f32_16x16x32_bf16 v[100:103], v[8:11], a[240:243], v[100:103]
    v_mfma_f32_16x16x32_bf16 v[96:99], v[8:11], a[116:119], v[96:99]
    v_mfma_f32_16x16x32_bf16 v[100:103], v[8:11], a[244:247], v[100:103]
    v_mfma_f32_16x16x32_bf16 v[96:99], v[8:11], a[120:123], v[96:99]
    v_mfma_f32_16x16x32_bf16 v[100:103], v[8:11], a[248:251], v[100:103]
    v_mfma_f32_16x16x32_bf16 v[96:99], v[8:11], a[124:127], v[96:99]
    v_mfma_f32_16x16x32_bf16 v[100:103], v[8:11], a[252:255], v[100:103]
    s_mov_b64 exec, 1
    global_store_dword v2, v3, s[44:45] offset:0 sc1
    s_mov_b64 exec, -1
    s_nop 1
    v_cmp_ne_u32 vcc, 0, v229
    s_cmp_eq_u64 vcc, 0
    s_cselect_b32 s100, 1, 0
    v_and_b32 v97, 0xffff0000, v96
    v_sub_f32 v98, v96, v97
    v_and_b32 v99, 0xffff0000, v98
    v_sub_f32 v98, v98, v99
    v_lshrrev_b32 v97, 16, v97
    v_or_b32 v16, v97, v99
    v_lshrrev_b32 v17, 16, v98
    v_mov_b32 v18, 0
    v_mov_b32 v19, 0
    v_and_b32 v101, 0xffff0000, v100
    v_sub_f32 v102, v100, v101
    v_and_b32 v103, 0xffff0000, v102
    v_sub_f32 v102, v102, v103
    v_lshrrev_b32 v101, 16, v101
    v_or_b32 v20, v101, v103
    v_lshrrev_b32 v21, 16, v102
    v_mov_b32 v22, 0
    v_mov_b32 v23, 0
    s_lshl_b32 s64, s49, 3
    s_lshl_b32 s65, s46, 2
    s_add_u32 s64, s64, s65
    s_add_u32 s64, s64, 45056
    v_mov_b32_e64 v2, s64
    s_lshl_b32 s64, s50, 7
    s_add_u32 s64, s64, 45056
    v_add_u32 v35, s64, v35
    s_waitcnt vmcnt(9)
    ds_read_b64_tr_b16 v[128:129], v244 offset:0
    ds_read_b64_tr_b16 v[130:131], v244 offset:1024
    ds_read_b64_tr_b16 v[132:133], v245 offset:0
    ds_read_b64_tr_b16 v[134:135], v245 offset:1024
    ds_read_b64_tr_b16 v[136:137], v244 offset:2048
    ds_read_b64_tr_b16 v[138:139], v244 offset:3072
    ds_read_b64_tr_b16 v[140:141], v245 offset:2048
    ds_read_b64_tr_b16 v[142:143], v245 offset:3072
    ds_read_b64_tr_b16 v[144:145], v244 offset:4096
    ds_read_b64_tr_b16 v[146:147], v244 offset:5120
    ds_read_b64_tr_b16 v[148:149], v245 offset:4096
    ds_read_b64_tr_b16 v[150:151], v245 offset:5120
    ds_read_b64_tr_b16 v[152:153], v244 offset:6144
    ds_read_b64_tr_b16 v[154:155], v244 offset:7168
    ds_read_b64_tr_b16 v[156:157], v245 offset:6144
    ds_read_b64_tr_b16 v[158:159], v245 offset:7168
    s_waitcnt vmcnt(1)
    ds_read_b64_tr_b16 v[160:161], v244 offset:8192
    ds_read_b64_tr_b16 v[162:163], v244 offset:9216
    ds_read_b64_tr_b16 v[164:165], v245 offset:8192
    ds_read_b64_tr_b16 v[166:167], v245 offset:9216
    ds_read_b64_tr_b16 v[168:169], v244 offset:10240
    s_nop 0
    ds_read_b64_tr_b16 v[170:171], v244 offset:11264
    ds_read_b64_tr_b16 v[172:173], v245 offset:10240
    ds_read_b64_tr_b16 v[174:175], v245 offset:11264
    ds_read_b64_tr_b16 v[176:177], v244 offset:12288
    ds_read_b64_tr_b16 v[178:179], v244 offset:13312
    ds_read_b64_tr_b16 v[180:181], v245 offset:12288
    ds_read_b64_tr_b16 v[182:183], v245 offset:13312
    ds_read_b64_tr_b16 v[184:185], v244 offset:14336
    ds_read_b64_tr_b16 v[186:187], v244 offset:15360
    ds_read_b64_tr_b16 v[188:189], v245 offset:14336
    ds_read_b64_tr_b16 v[190:191], v245 offset:15360
L_g1s_6:
    s_barrier
    ds_read_b64_tr_b16 v[40:41], v250 offset:0
    ds_read_b64_tr_b16 v[42:43], v250 offset:1024
    ds_read_b64_tr_b16 v[44:45], v250 offset:2048
    ds_read_b64_tr_b16 v[46:47], v250 offset:3072
    s_nop 0
    ds_read_b64_tr_b16 v[48:49], v250 offset:4096
    ds_read_b64_tr_b16 v[50:51], v250 offset:5120
    ds_read_b64_tr_b16 v[52:53], v250 offset:6144
    ds_read_b64_tr_b16 v[54:55], v250 offset:7168
    s_waitcnt lgkmcnt(6)
    v_mfma_f32_32x32x16_bf16 v[64:79], a[0:3], v[40:43], 0
    ds_read_b64_tr_b16 v[56:57], v250 offset:8192
    ds_read_b64_tr_b16 v[58:59], v250 offset:9216
    s_nop 0
    v_mfma_f32_32x32x16_bf16 v[80:95], a[128:131], v[40:43], 0
    s_add_u32 m0, s68, 40960
    s_add_u32 s66, s69, 1310720
    buffer_load_dwordx4 v36, s[56:59], s66 offen offset:0 sc1 lds
    buffer_load_dwordx4 v37, s[56:59], s66 offen offset:1024 sc1 lds
    s_waitcnt lgkmcnt(6)
    v_mfma_f32_32x32x16_bf16 v[64:79], a[4:7], v[44:47], v[64:79]
    ds_read_b64_tr_b16 v[60:61], v250 offset:10240
    s_nop 0
    ds_read_b64_tr_b16 v[62:63], v250 offset:11264
    v_mfma_f32_32x32x16_bf16 v[80:95], a[132:135], v[44:47], v[80:95]
    buffer_load_dwordx4 v38, s[56:59], s66 offen offset:2048 sc1 lds
    s_barrier
    s_waitcnt lgkmcnt(6)
    v_mfma_f32_32x32x16_bf16 v[64:79], a[8:11], v[48:51], v[64:79]
    ds_read_b64_tr_b16 v[40:41], v250 offset:12288
    ds_read_b64_tr_b16 v[42:43], v250 offset:13312
    v_mfma_f32_32x32x16_bf16 v[80:95], a[136:139], v[48:51], v[80:95]
    buffer_load_dwordx4 v39, s[56:59], s66 offen offset:3072 sc1 lds
    s_add_u32 m0, s68, 53248
    s_add_u32 s66, s69, 1703936
    buffer_load_dwordx4 v36, s[56:59], s66 offen offset:0 sc1 lds
    s_waitcnt lgkmcnt(6)
    v_mfma_f32_32x32x16_bf16 v[64:79], a[12:15], v[52:55], v[64:79]
    ds_read_b64_tr_b16 v[44:45], v250 offset:14336
    ds_read_b64_tr_b16 v[46:47], v250 offset:15360
    s_nop 0
    v_mfma_f32_32x32x16_bf16 v[80:95], a[140:143], v[52:55], v[80:95]
    buffer_load_dwordx4 v37, s[56:59], s66 offen offset:1024 sc1 lds
    s_waitcnt lgkmcnt(6)
    v_mfma_f32_32x32x16_bf16 v[64:79], a[16:19], v[56:59], v[64:79]
    ds_read_b64_tr_b16 v[48:49], v250 offset:16384
    ds_read_b64_tr_b16 v[50:51], v250 offset:17408
    v_mfma_f32_32x32x16_bf16 v[80:95], a[144:147], v[56:59], v[80:95]
    buffer_load_dwordx4 v38, s[56:59], s66 offen offset:2048 sc1 lds
    s_nop 0
    buffer_load_dwordx4 v39, s[56:59], s66 offen offset:3072 sc1 lds
    s_waitcnt lgkmcnt(6)
    v_mfma_f32_32x32x16_bf16 v[64:79], a[20:23], v[60:63], v[64:79]
    ds_read_b64_tr_b16 v[52:53], v250 offset:18432
    v_mfma_f32_32x32x16_bf16 v[80:95], a[148:151], v[60:63], v[80:95]
    ds_read_b64_tr_b16 v[54:55], v250 offset:19456
    s_waitcnt lgkmcnt(6)
    v_mfma_f32_32x32x16_bf16 v[64:79], a[24:27], v[40:43], v[64:79]
    ds_read_b64_tr_b16 v[56:57], v250 offset:20480
    v_mfma_f32_32x32x16_bf16 v[80:95], a[152:155], v[40:43], v[80:95]
    ds_read_b64_tr_b16 v[58:59], v250 offset:21504
    s_waitcnt lgkmcnt(6)
    v_mfma_f32_32x32x16_bf16 v[64:79], a[28:31], v[44:47], v[64:79]
    ds_read_b64_tr_b16 v[60:61], v250 offset:22528
    v_mfma_f32_32x32x16_bf16 v[80:95], a[156:159], v[44:47], v[80:95]
    ds_read_b64_tr_b16 v[62:63], v250 offset:23552
    s_waitcnt lgkmcnt(6)
    v_mfma_f32_32x32x16_bf16 v[64:79], a[32:35], v[48:51], v[64:79]
    ds_read_b64_tr_b16 v[40:41], v250 offset:24576
    v_mfma_f32_32x32x16_bf16 v[80:95], a[160:163], v[48:51], v[80:95]
    ds_read_b64_tr_b16 v[42:43], v250 offset:25600
    s_waitcnt lgkmcnt(6)
    v_mfma_f32_32x32x16_bf16 v[64:79], a[36:39], v[52:55], v[64:79]
    ds_read_b64_tr_b16 v[44:45], v250 offset:26624
    v_mfma_f32_32x32x16_bf16 v[80:95], a[164:167], v[52:55], v[80:95]
    ds_read_b64_tr_b16 v[46:47], v250 offset:27648
    s_barrier
    s_waitcnt lgkmcnt(6)
    v_mfma_f32_32x32x16_bf16 v[64:79], a[40:43], v[56:59], v[64:79]
    ds_read_b64_tr_b16 v[48:49], v250 offset:28672
    v_mfma_f32_32x32x16_bf16 v[80:95], a[168:171], v[56:59], v[80:95]
    ds_read_b64_tr_b16 v[50:51], v250 offset:29696
    s_waitcnt lgkmcnt(6)
    v_mfma_f32_32x32x16_bf16 v[64:79], a[44:47], v[60:63], v[64:79]
    ds_read_b64_tr_b16 v[52:53], v250 offset:30720
    ds_read_b64_tr_b16 v[54:55], v250 offset:31744
    v_mfma_f32_32x32x16_bf16 v[80:95], a[172:175], v[60:63], v[80:95]
    s_add_u32 m0, s61, 0
    s_lshl3_add_u32 s15, s20, s14
    buffer_load_dwordx4 v240, s[52:55], s15 offen offset:0  lds
    s_waitcnt lgkmcnt(6)
    v_mfma_f32_32x32x16_bf16 v[64:79], a[48:51], v[40:43], v[64:79]
    ds_read_b64_tr_b16 v[56:57], v250 offset:32768
    ds_read_b64_tr_b16 v[58:59], v250 offset:33792
    v_mfma_f32_32x32x16_bf16 v[80:95], a[176:179], v[40:43], v[80:95]
    s_nop 0
    buffer_load_dwordx4 v241, s[52:55], s15 offen offset:1024  lds
    s_waitcnt lgkmcnt(6)
    v_mfma_f32_32x32x16_bf16 v[64:79], a[52:55], v[44:47], v[64:79]
    ds_read_b64_tr_b16 v[60:61], v250 offset:34816
    ds_read_b64_tr_b16 v[62:63], v250 offset:35840
    v_mfma_f32_32x32x16_bf16 v[80:95], a[180:183], v[44:47], v[80:95]
    buffer_load_dwordx4 v242, s[52:55], s15 offen offset:2048  lds
    s_waitcnt lgkmcnt(6)
    v_mfma_f32_32x32x16_bf16 v[64:79], a[56:59], v[48:51], v[64:79]
    ds_read_b64_tr_b16 v[40:41], v250 offset:36864
    v_mfma_f32_32x32x16_bf16 v[80:95], a[184:187], v[48:51], v[80:95]
    ds_read_b64_tr_b16 v[42:43], v250 offset:37888
    s_waitcnt lgkmcnt(6)
    v_mfma_f32_32x32x16_bf16 v[64:79], a[60:63], v[52:55], v[64:79]
    ds_read_b64_tr_b16 v[44:45], v250 offset:38912
    ds_read_b64_tr_b16 v[46:47], v250 offset:39936
    v_mfma_f32_32x32x16_bf16 v[80:95], a[188:191], v[52:55], v[80:95]
    s_nop 0
    buffer_load_dwordx4 v243, s[52:55], s15 offen offset:3072  lds
    s_waitcnt vmcnt(8)
    s_barrier
    s_waitcnt lgkmcnt(6)
    v_mfma_f32_32x32x16_bf16 v[64:79], a[64:67], v[56:59], v[64:79]
    ds_read_b64_tr_b16 v[48:49], v250 offset:40960
    ds_read_b64_tr_b16 v[50:51], v250 offset:41984
    v_mfma_f32_32x32x16_bf16 v[80:95], a[192:195], v[56:59], v[80:95]
    s_add_u32 m0, s61, 4096
    s_lshl3_add_u32 s15, s21, s14
    buffer_load_dwordx4 v240, s[52:55], s15 offen offset:0  lds
    s_waitcnt lgkmcnt(6)
    v_mfma_f32_32x32x16_bf16 v[64:79], a[68:71], v[60:63], v[64:79]
    ds_read_b64_tr_b16 v[52:53], v250 offset:43008
    ds_read_b64_tr_b16 v[54:55], v250 offset:44032
    v_mfma_f32_32x32x16_bf16 v[80:95], a[196:199], v[60:63], v[80:95]
    buffer_load_dwordx4 v241, s[52:55], s15 offen offset:1024  lds
    s_waitcnt lgkmcnt(6)
    v_mfma_f32_32x32x16_bf16 v[64:79], a[72:75], v[40:43], v[64:79]
    ds_read_b64_tr_b16 v[56:57], v250 offset:45056
    v_mfma_f32_32x32x16_bf16 v[80:95], a[200:203], v[40:43], v[80:95]
    ds_read_b64_tr_b16 v[58:59], v250 offset:46080
    s_waitcnt lgkmcnt(6)
    v_mfma_f32_32x32x16_bf16 v[64:79], a[76:79], v[44:47], v[64:79]
    ds_read_b64_tr_b16 v[60:61], v250 offset:47104
    ds_read_b64_tr_b16 v[62:63], v250 offset:48128
    v_mfma_f32_32x32x16_bf16 v[80:95], a[204:207], v[44:47], v[80:95]
    s_nop 0
    buffer_load_dwordx4 v242, s[52:55], s15 offen offset:2048  lds
    s_waitcnt lgkmcnt(6)
    v_mfma_f32_32x32x16_bf16 v[64:79], a[80:83], v[48:51], v[64:79]
    ds_read_b64_tr_b16 v[40:41], v250 offset:49152
    ds_read_b64_tr_b16 v[42:43], v250 offset:50176
    v_mfma_f32_32x32x16_bf16 v[80:95], a[208:211], v[48:51], v[80:95]
    buffer_load_dwordx4 v243, s[52:55], s15 offen offset:3072  lds
    s_waitcnt lgkmcnt(6)
    v_mfma_f32_32x32x16_bf16 v[64:79], a[84:87], v[52:55], v[64:79]
    ds_read_b64_tr_b16 v[44:45], v250 offset:51200
    ds_read_b64_tr_b16 v[46:47], v250 offset:52224
    v_mfma_f32_32x32x16_bf16 v[80:95], a[212:215], v[52:55], v[80:95]
    s_add_u32 m0, s60, 0
    s_lshl3_add_u32 s15, s22, s14
    buffer_load_dwordx4 v240, s[52:55], s15 offen offset:0  lds
    s_waitcnt vmcnt(9)
    s_barrier
    s_waitcnt lgkmcnt(6)
    v_mfma_f32_32x32x16_bf16 v[64:79], a[88:91], v[56:59], v[64:79]
    s_nop 0
    ds_read_b64_tr_b16 v[48:49], v250 offset:53248
    v_mfma_f32_32x32x16_bf16 v[80:95], a[216:219], v[56:59], v[80:95]
    ds_read_b64_tr_b16 v[50:51], v250 offset:54272
    s_waitcnt lgkmcnt(6)
    v_mfma_f32_32x32x16_bf16 v[64:79], a[92:95], v[60:63], v[64:79]
    ds_read_b64_tr_b16 v[52:53], v250 offset:55296
    ds_read_b64_tr_b16 v[54:55], v250 offset:56320
    v_mfma_f32_32x32x16_bf16 v[80:95], a[220:223], v[60:63], v[80:95]
    s_nop 0
    buffer_load_dwordx4 v241, s[52:55], s15 offen offset:1024  lds
    s_waitcnt lgkmcnt(6)
    v_mfma_f32_32x32x16_bf16 v[64:79], a[96:99], v[40:43], v[64:79]
    ds_read_b64_tr_b16 v[56:57], v250 offset:57344
    ds_read_b64_tr_b16 v[58:59], v250 offset:58368
    v_mfma_f32_32x32x16_bf16 v[80:95], a[224:227], v[40:43], v[80:95]
    buffer_load_dwordx4 v242, s[52:55], s15 offen offset:2048  lds
    s_waitcnt lgkmcnt(6)
    v_mfma_f32_32x32x16_bf16 v[64:79], a[100:103], v[44:47], v[64:79]
    ds_read_b64_tr_b16 v[60:61], v250 offset:59392
    ds_read_b64_tr_b16 v[62:63], v250 offset:60416
    v_mfma_f32_32x32x16_bf16 v[80:95], a[228:231], v[44:47], v[80:95]
    buffer_load_dwordx4 v243, s[52:55], s15 offen offset:3072  lds
    s_waitcnt lgkmcnt(6)
    v_mfma_f32_32x32x16_bf16 v[64:79], a[104:107], v[48:51], v[64:79]
    ds_read_b64_tr_b16 v[40:41], v250 offset:61440
    v_mfma_f32_32x32x16_bf16 v[80:95], a[232:235], v[48:51], v[80:95]
    s_nop 0
    ds_read_b64_tr_b16 v[42:43], v250 offset:62464
    s_waitcnt lgkmcnt(6)
    v_mfma_f32_32x32x16_bf16 v[64:79], a[108:111], v[52:55], v[64:79]
    ds_read_b64_tr_b16 v[44:45], v250 offset:63488
    ds_read_b64_tr_b16 v[46:47], v250 offset:64512
    v_mfma_f32_32x32x16_bf16 v[80:95], a[236:239], v[52:55], v[80:95]
    s_add_u32 m0, s60, 4096
    s_lshl3_add_u32 s15, s23, s14
    buffer_load_dwordx4 v240, s[52:55], s15 offen offset:0  lds
    s_waitcnt lgkmcnt(6)
    v_mfma_f32_32x32x16_bf16 v[64:79], a[112:115], v[56:59], v[64:79]
    ds_read_b64_tr_b16 v[48:49], v251 offset:0
    ds_read_b64_tr_b16 v[50:51], v251 offset:1024
    v_mfma_f32_32x32x16_bf16 v[80:95], a[240:243], v[56:59], v[80:95]
    buffer_load_dwordx4 v241, s[52:55], s15 offen offset:1024  lds
    s_waitcnt lgkmcnt(6)
    v_mfma_f32_32x32x16_bf16 v[64:79], a[116:119], v[60:63], v[64:79]
    ds_read_b64_tr_b16 v[52:53], v251 offset:2048
    ds_read_b64_tr_b16 v[54:55], v251 offset:3072
    v_mfma_f32_32x32x16_bf16 v[80:95], a[244:247], v[60:63], v[80:95]
    buffer_load_dwordx4 v242, s[52:55], s15 offen offset:2048  lds
    s_waitcnt lgkmcnt(6)
    v_mfma_f32_32x32x16_bf16 v[64:79], a[120:123], v[40:43], v[64:79]
    ds_read_b64_tr_b16 v[56:57], v251 offset:4096
    ds_read_b64_tr_b16 v[58:59], v251 offset:5120
    s_waitcnt vmcnt(7)
    ds_read_b64_tr_b16 v[192:193], v246 offset:0
    v_mfma_f32_32x32x16_bf16 v[80:95], a[248:251], v[40:43], v[80:95]
    ds_read_b64_tr_b16 v[194:195], v246 offset:1024
    ds_read_b64_tr_b16 v[196:197], v247 offset:0
    ds_read_b64_tr_b16 v[198:199], v247 offset:1024
    s_waitcnt lgkmcnt(10)
    v_mfma_f32_32x32x16_bf16 v[64:79], a[124:127], v[44:47], v[64:79]
    ds_read_b64_tr_b16 v[60:61], v251 offset:6144
    ds_read_b64_tr_b16 v[62:63], v251 offset:7168
    s_nop 0
    ds_read_b64_tr_b16 v[200:201], v246 offset:2048
    ds_read_b64_tr_b16 v[202:203], v246 offset:3072
    v_mfma_f32_32x32x16_bf16 v[80:95], a[252:255], v[44:47], v[80:95]
    ds_read_b64_tr_b16 v[204:205], v247 offset:2048
    ds_read_b64_tr_b16 v[206:207], v247 offset:3072
    buffer_load_dwordx4 v243, s[52:55], s15 offen offset:3072  lds
    s_waitcnt lgkmcnt(14)
    v_mfma_f32_32x32x16_bf16 v[96:111], a[0:3], v[48:51], 0
    s_nop 0
    ds_read_b64_tr_b16 v[40:41], v251 offset:8192
    ds_read_b64_tr_b16 v[42:43], v251 offset:9216
    ds_read_b64_tr_b16 v[208:209], v246 offset:4096
    ds_read_b64_tr_b16 v[210:211], v246 offset:5120
    v_mfma_f32_32x32x16_bf16 v[112:127], a[128:131], v[48:51], 0
    ds_read_b64_tr_b16 v[212:213], v247 offset:4096
    ds_read_b64_tr_b16 v[214:215], v247 offset:5120
    s_add_u32 m0, s60, 8192
    s_lshl3_add_u32 s15, s24, s14
    buffer_load_dwordx4 v240, s[52:55], s15 offen offset:0  lds
    s_waitcnt lgkmcnt(14)
    v_mfma_f32_32x32x16_bf16 v[96:111], a[4:7], v[52:55], v[96:111]
    ds_read_b64_tr_b16 v[44:45], v251 offset:10240
    ds_read_b64_tr_b16 v[46:47], v251 offset:11264
    ds_read_b64_tr_b16 v[216:217], v246 offset:6144
    ds_read_b64_tr_b16 v[218:219], v246 offset:7168
    v_mfma_f32_32x32x16_bf16 v[112:127], a[132:135], v[52:55], v[112:127]
    ds_read_b64_tr_b16 v[220:221], v247 offset:6144
    ds_read_b64_tr_b16 v[222:223], v247 offset:7168
    buffer_load_dwordx4 v241, s[52:55], s15 offen offset:1024  lds
    s_barrier
    ds_read2_b32 v[32:33], v34 offset0:0 offset1:32
    v_mfma_f32_32x32x16_bf16 v[96:111], a[8:11], v[56:59], v[96:111]
    ds_read_b64_tr_b16 v[48:49], v251 offset:12288
    v_mfma_f32_32x32x16_bf16 v[112:127], a[136:139], v[56:59], v[112:127]
    s_nop 0
    ds_read_b64_tr_b16 v[50:51], v251 offset:13312
    s_waitcnt lgkmcnt(14)
    v_mfma_f32_32x32x16_bf16 v[96:111], a[12:15], v[60:63], v[96:111]
    ds_read_b64_tr_b16 v[52:53], v251 offset:14336
    ds_read_b64_tr_b16 v[54:55], v251 offset:15360
    v_mfma_f32_32x32x16_bf16 v[112:127], a[140:143], v[60:63], v[112:127]
    buffer_load_dwordx4 v242, s[52:55], s15 offen offset:2048  lds
    s_waitcnt lgkmcnt(4)
    v_cmp_u_f32 vcc, v32, v33
    s_and_b64 vcc, vcc, s[34:35]
    s_cbranch_scc1 L_g1r_7
    v_mfma_f32_32x32x16_bf16 v[96:111], a[16:19], v[40:43], v[96:111]
    ds_read_b64_tr_b16 v[56:57], v251 offset:16384
    ds_read_b64_tr_b16 v[58:59], v251 offset:17408
    v_cvt_pk_bf16_f32 v24, -v32, -v32
    v_cndmask_b32 v24, 0, v24, s[70:71]
    v_and_b32 v25, 0xffff, v24
    v_mfma_f32_32x32x16_bf16 v[112:127], a[144:147], v[40:43], v[112:127]
    s_nop 0
    buffer_load_dwordx4 v243, s[52:55], s15 offen offset:3072  lds
    v_cvt_pk_bf16_f32 v28, -v33, -v33
    v_cndmask_b32 v28, 0, v28, s[70:71]
    v_and_b32 v29, 0xffff, v28
    v_mfma_f32_32x32x16_bf16 v[96:111], a[20:23], v[44:47], v[96:111]
    ds_read_b64_tr_b16 v[60:61], v251 offset:18432
    ds_read_b64_tr_b16 v[62:63], v251 offset:19456
    v_mfma_f32_32x32x16_bf16 v[112:127], a[148:151], v[44:47], v[112:127]
    s_add_u32 m0, s60, 12288
    s_lshl3_add_u32 s15, s25, s14
    buffer_load_dwordx4 v240, s[52:55], s15 offen offset:0  lds
    v_mfma_f32_32x32x16_bf16 v[64:79], v[16:19], v[24:27], v[64:79]
    v_mfma_f32_32x32x16_bf16 v[80:95], v[20:23], v[24:27], v[80:95]
    v_mfma_f32_32x32x16_bf16 v[96:111], v[16:19], v[28:31], v[96:111]
    v_mfma_f32_32x32x16_bf16 v[112:127], v[20:23], v[28:31], v[112:127]
    s_barrier
    s_waitcnt lgkmcnt(6)
    s_nop 0
    v_mfma_f32_32x32x16_bf16 v[96:111], a[24:27], v[48:51], v[96:111]
    ds_read_b64_tr_b16 v[40:41], v251 offset:20480
    v_mfma_f32_32x32x16_bf16 v[112:127], a[152:155], v[48:51], v[112:127]
    ds_read_b64_tr_b16 v[42:43], v251 offset:21504
    s_waitcnt lgkmcnt(6)
    v_mfma_f32_32x32x16_bf16 v[96:111], a[28:31], v[52:55], v[96:111]
    ds_read_b64_tr_b16 v[44:45], v251 offset:22528
    ds_read_b64_tr_b16 v[46:47], v251 offset:23552
    s_nop 0
    v_mfma_f32_32x32x16_bf16 v[112:127], a[156:159], v[52:55], v[112:127]
    buffer_load_dwordx4 v241, s[52:55], s15 offen offset:1024  lds
    s_waitcnt lgkmcnt(6)
    v_mfma_f32_32x32x16_bf16 v[96:111], a[32:35], v[56:59], v[96:111]
    ds_read_b64_tr_b16 v[48:49], v251 offset:24576
    ds_read_b64_tr_b16 v[50:51], v251 offset:25600
    v_cvt_pk_bf16_f32 v64, v64, v65
    v_cvt_pk_bf16_f32 v65, v66, v67
    s_nop 0
    v_cvt_pk_bf16_f32 v66, v68, v69
    v_mfma_f32_32x32x16_bf16 v[112:127], a[160:163], v[56:59], v[112:127]
    buffer_load_dwordx4 v242, s[52:55], s15 offen offset:2048  lds
    v_cvt_pk_bf16_f32 v67, v70, v71
    v_pk_max_i16 v64, v64, 0
    v_pk_max_i16 v65, v65, 0
    s_waitcnt lgkmcnt(6)
    v_mfma_f32_32x32x16_bf16 v[96:111], a[36:39], v[60:63], v[96:111]
    s_nop 0
    ds_read_b64_tr_b16 v[52:53], v251 offset:26624
    ds_read_b64_tr_b16 v[54:55], v251 offset:27648
    v_pk_max_i16 v66, v66, 0
    v_pk_max_i16 v67, v67, 0
    s_cmp_eq_u32 s100, 0
    s_cbranch_scc1 L_stg_25
    global_store_dwordx4 v236, v[64:67], s[44:45] offset:-4096 nt
L_stb_26:
    v_mfma_f32_32x32x16_bf16 v[112:127], a[164:167], v[60:63], v[112:127]
    buffer_load_dwordx4 v243, s[52:55], s15 offen offset:3072  lds
    v_cvt_pk_bf16_f32 v68, v72, v73
    v_cvt_pk_bf16_f32 v69, v74, v75
    v_cvt_pk_bf16_f32 v70, v76, v77
    s_waitcnt lgkmcnt(6)
    v_mfma_f32_32x32x16_bf16 v[96:111], a[40:43], v[40:43], v[96:111]
    ds_read_b64_tr_b16 v[56:57], v251 offset:28672
    v_cvt_pk_bf16_f32 v71, v78, v79
    v_pk_max_i16 v68, v68, 0
    s_nop 0
    v_pk_max_i16 v69, v69, 0
    v_mfma_f32_32x32x16_bf16 v[112:127], a[168:171], v[40:43], v[112:127]
    ds_read_b64_tr_b16 v[58:59], v251 offset:29696
    v_pk_max_i16 v70, v70, 0
    v_pk_max_i16 v71, v71, 0
    s_cmp_eq_u32 s100, 0
    s_cbranch_scc1 L_stg_27
    global_store_dwordx4 v236, v[68:71], s[44:45] offset:-2048 nt
L_stb_28:
    s_waitcnt lgkmcnt(6)
    s_nop 0
    v_mfma_f32_32x32x16_bf16 v[96:111], a[44:47], v[44:47], v[96:111]
    ds_read_b64_tr_b16 v[60:61], v251 offset:30720
    ds_read_b64_tr_b16 v[62:63], v251 offset:31744
    v_cvt_pk_bf16_f32 v72, v80, v81
    v_cvt_pk_bf16_f32 v73, v82, v83
    v_cvt_pk_bf16_f32 v74, v84, v85
    v_mfma_f32_32x32x16_bf16 v[112:127], a[172:175], v[44:47], v[112:127]
    s_add_u32 m0, s61, 0
    s_lshl3_add_u32 s15, s26, s14
    buffer_load_dwordx4 v240, s[52:55], s15 offen offset:0  lds
    v_cvt_pk_bf16_f32 v75, v86, v87
    v_pk_max_i16 v72, v72, 0
    v_pk_max_i16 v73, v73, 0
    s_waitcnt lgkmcnt(6)
    v_mfma_f32_32x32x16_bf16 v[96:111], a[48:51], v[48:51], v[96:111]
    ds_read_b64_tr_b16 v[40:41], v251 offset:32768
    ds_read_b64_tr_b16 v[42:43], v251 offset:33792
    s_nop 0
    v_pk_max_i16 v74, v74, 0
    v_pk_max_i16 v75, v75, 0
    s_cmp_eq_u32 s100, 0
    s_cbranch_scc1 L_stg_29
    global_store_dwordx4 v236, v[72:75], s[44:45] offset:0 nt
L_stb_30:
    v_mfma_f32_32x32x16_bf16 v[112:127], a[176:179], v[48:51], v[112:127]
    buffer_load_dwordx4 v241, s[52:55], s15 offen offset:1024  lds
    v_cvt_pk_bf16_f32 v76, v88, v89
    v_cvt_pk_bf16_f32 v77, v90, v91
    v_cvt_pk_bf16_f32 v78, v92, v93
    s_waitcnt lgkmcnt(6)
    v_mfma_f32_32x32x16_bf16 v[96:111], a[52:55], v[52:55], v[96:111]
    ds_read_b64_tr_b16 v[44:45], v251 offset:34816
    ds_read_b64_tr_b16 v[46:47], v251 offset:35840
    v_cvt_pk_bf16_f32 v79, v94, v95
    v_pk_max_i16 v76, v76, 0
    v_pk_max_i16 v77, v77, 0
    s_nop 0
    v_mfma_f32_32x32x16_bf16 v[112:127], a[180:183], v[52:55], v[112:127]
    buffer_load_dwordx4 v242, s[52:55], s15 offen offset:2048  lds
    v_pk_max_i16 v78, v78, 0
    v_pk_max_i16 v79, v79, 0
    s_cmp_eq_u32 s100, 0
    s_cbranch_scc1 L_stg_31
    global_store_dwordx4 v236, v[76:79], s[44:45] offset:2048 nt
L_stb_32:
    s_waitcnt lgkmcnt(6)
    v_mfma_f32_32x32x16_bf16 v[96:111], a[56:59], v[56:59], v[96:111]
    s_nop 0
    ds_read_b64_tr_b16 v[48:49], v251 offset:36864
    ds_read_b64_tr_b16 v[50:51], v251 offset:37888
    s_waitcnt vmcnt(15)
    ds_read_b64_tr_b16 a[0:1], v244 offset:0
    v_mfma_f32_32x32x16_bf16 v[112:127], a[184:187], v[56:59], v[112:127]
    ds_read_b64_tr_b16 a[2:3], v244 offset:1024
    ds_read_b64_tr_b16 a[128:129], v245 offset:0
    ds_read_b64_tr_b16 a[130:131], v245 offset:1024
    s_waitcnt lgkmcnt(10)
    v_mfma_f32_32x32x16_bf16 v[96:111], a[60:63], v[60:63], v[96:111]
    ds_read_b64_tr_b16 v[52:53], v251 offset:38912
    ds_read_b64_tr_b16 v[54:55], v251 offset:39936
    ds_read_b64_tr_b16 a[4:5], v244 offset:2048
    ds_read_b64_tr_b16 a[6:7], v244 offset:3072
    v_mfma_f32_32x32x16_bf16 v[112:127], a[188:191], v[60:63], v[112:127]
    ds_read_b64_tr_b16 a[132:133], v245 offset:2048
    ds_read_b64_tr_b16 a[134:135], v245 offset:3072
    buffer_load_dwordx4 v243, s[52:55], s15 offen offset:3072  lds
    s_waitcnt lgkmcnt(14)
    v_mfma_f32_32x32x16_bf16 v[96:111], a[64:67], v[40:43], v[96:111]
    ds_read_b64_tr_b16 v[56:57], v251 offset:40960
    ds_read_b64_tr_b16 v[58:59], v251 offset:41984
    ds_read_b64_tr_b16 a[8:9], v244 offset:4096
    ds_read_b64_tr_b16 a[10:11], v244 offset:5120
    v_mfma_f32_32x32x16_bf16 v[112:127], a[192:195], v[40:43], v[112:127]
    s_nop 0
    ds_read_b64_tr_b16 a[136:137], v245 offset:4096
    ds_read_b64_tr_b16 a[138:139], v245 offset:5120
    s_add_u32 m0, s61, 4096
    s_lshl3_add_u32 s15, s27, s14
    buffer_load_dwordx4 v240, s[52:55], s15 offen offset:0  lds
    s_waitcnt lgkmcnt(14)
    v_mfma_f32_32x32x16_bf16 v[96:111], a[68:71], v[44:47], v[96:111]
    ds_read_b64_tr_b16 v[60:61], v251 offset:43008
    ds_read_b64_tr_b16 v[62:63], v251 offset:44032
    ds_read_b64_tr_b16 a[12:13], v244 offset:6144
    ds_read_b64_tr_b16 a[14:15], v244 offset:7168
    v_mfma_f32_32x32x16_bf16 v[112:127], a[196:199], v[44:47], v[112:127]
    ds_read_b64_tr_b16 a[140:141], v245 offset:6144
    ds_read_b64_tr_b16 a[142:143], v245 offset:7168
    buffer_load_dwordx4 v241, s[52:55], s15 offen offset:1024  lds
    v_mfma_f32_32x32x16_bf16 v[96:111], a[72:75], v[48:51], v[96:111]
    ds_read_b64_tr_b16 v[40:41], v251 offset:45056
    v_mfma_f32_32x32x16_bf16 v[112:127], a[200:203], v[48:51], v[112:127]
    ds_read_b64_tr_b16 v[42:43], v251 offset:46080
    s_waitcnt lgkmcnt(14)
    v_mfma_f32_32x32x16_bf16 v[96:111], a[76:79], v[52:55], v[96:111]
    ds_read_b64_tr_b16 v[44:45], v251 offset:47104
    ds_read_b64_tr_b16 v[46:47], v251 offset:48128
    v_mfma_f32_32x32x16_bf16 v[112:127], a[204:207], v[52:55], v[112:127]
    buffer_load_dwordx4 v242, s[52:55], s15 offen offset:2048  lds
    s_waitcnt lgkmcnt(14)
    v_mfma_f32_32x32x16_bf16 v[96:111], a[80:83], v[56:59], v[96:111]
    ds_read_b64_tr_b16 v[48:49], v251 offset:49152
    ds_read_b64_tr_b16 v[50:51], v251 offset:50176
    s_waitcnt vmcnt(4)
    v_mfma_f32_32x32x16_bf16 v[112:127], a[208:211], v[56:59], v[112:127]
    buffer_load_dwordx4 v243, s[52:55], s15 offen offset:3072  lds
    s_cmp_eq_u32 s100, 0
    s_mov_b64 exec, 1
    s_cbranch_scc1 L_stg_33
    global_store_dword v2, v3, s[44:45]
L_stb_34:
    s_mov_b64 exec, -1
    s_waitcnt lgkmcnt(10)
    v_mfma_f32_32x32x16_bf16 v[96:111], a[84:87], v[60:63], v[96:111]
    ds_read_b64_tr_b16 v[52:53], v251 offset:51200
    v_mfma_f32_32x32x16_bf16 v[112:127], a[212:215], v[60:63], v[112:127]
    ds_read_b64_tr_b16 v[54:55], v251 offset:52224
    s_waitcnt lgkmcnt(6)
    v_mfma_f32_32x32x16_bf16 v[96:111], a[88:91], v[40:43], v[96:111]
    ds_read_b64_tr_b16 v[56:57], v251 offset:53248
    s_nop 0
    v_mfma_f32_32x32x16_bf16 v[112:127], a[216:219], v[40:43], v[112:127]
    ds_read_b64_tr_b16 v[58:59], v251 offset:54272
    s_waitcnt lgkmcnt(6)
    v_mfma_f32_32x32x16_bf16 v[96:111], a[92:95], v[44:47], v[96:111]
    ds_read_b64_tr_b16 v[60:61], v251 offset:55296
    v_mfma_f32_32x32x16_bf16 v[112:127], a[220:223], v[44:47], v[112:127]
    ds_read_b64_tr_b16 v[62:63], v251 offset:56320
    s_waitcnt lgkmcnt(6)
    v_mfma_f32_32x32x16_bf16 v[96:111], a[96:99], v[48:51], v[96:111]
    ds_read_b64_tr_b16 v[40:41], v251 offset:57344
    ds_read_b64_tr_b16 v[42:43], v251 offset:58368
    ds_read_b64_tr_b16 a[16:17], v244 offset:8192
    v_mfma_f32_32x32x16_bf16 v[112:127], a[224:227], v[48:51], v[112:127]
    ds_read_b64_tr_b16 a[18:19], v244 offset:9216
    ds_read_b64_tr_b16 a[144:145], v245 offset:8192
    ds_read_b64_tr_b16 a[146:147], v245 offset:9216
    s_waitcnt lgkmcnt(10)
    s_nop 0
    v_mfma_f32_32x32x16_bf16 v[96:111], a[100:103], v[52:55], v[96:111]
    ds_read_b64_tr_b16 v[44:45], v251 offset:59392
    ds_read_b64_tr_b16 v[46:47], v251 offset:60416
    ds_read_b64_tr_b16 a[20:21], v244 offset:10240
    v_mfma_f32_32x32x16_bf16 v[112:127], a[228:231], v[52:55], v[112:127]
    ds_read_b64_tr_b16 a[22:23], v244 offset:11264
    ds_read_b64_tr_b16 a[148:149], v245 offset:10240
    ds_read_b64_tr_b16 a[150:151], v245 offset:11264
    s_waitcnt lgkmcnt(14)
    v_mfma_f32_32x32x16_bf16 v[96:111], a[104:107], v[56:59], v[96:111]
    ds_read_b64_tr_b16 v[48:49], v251 offset:61440
    ds_read_b64_tr_b16 v[50:51], v251 offset:62464
    global_load_dword v238, v35, s[44:45] sc1
    ds_read_b64_tr_b16 a[24:25], v244 offset:12288
    v_mfma_f32_32x32x16_bf16 v[112:127], a[232:235], v[56:59], v[112:127]
    ds_read_b64_tr_b16 a[26:27], v244 offset:13312
    s_nop 0
    ds_read_b64_tr_b16 a[152:153], v245 offset:12288
    ds_read_b64_tr_b16 a[154:155], v245 offset:13312
    s_waitcnt lgkmcnt(14)
    v_mfma_f32_32x32x16_bf16 v[96:111], a[108:111], v[60:63], v[96:111]
    ds_read_b64_tr_b16 v[52:53], v251 offset:63488
    ds_read_b64_tr_b16 v[54:55], v251 offset:64512
    ds_read_b64_tr_b16 a[28:29], v244 offset:14336
    v_mfma_f32_32x32x16_bf16 v[112:127], a[236:239], v[60:63], v[112:127]
    s_nop 0
    ds_read_b64_tr_b16 a[30:31], v244 offset:15360
    ds_read_b64_tr_b16 a[156:157], v245 offset:14336
    ds_read_b64_tr_b16 a[158:159], v245 offset:15360
    v_mfma_f32_32x32x16_bf16 v[96:111], a[112:115], v[40:43], v[96:111]
    v_mfma_f32_32x32x16_bf16 v[112:127], a[240:243], v[40:43], v[112:127]
    s_waitcnt lgkmcnt(14)
    v_mfma_f32_32x32x16_bf16 v[96:111], a[116:119], v[44:47], v[96:111]
    s_waitcnt lgkmcnt(10)
    v_mfma_f32_32x32x16_bf16 v[96:111], a[120:123], v[48:51], v[96:111]
    s_waitcnt lgkmcnt(4)
    v_mfma_f32_32x32x16_bf16 v[96:111], a[124:127], v[52:55], v[96:111]
    v_mfma_f32_32x32x16_bf16 v[112:127], a[244:247], v[44:47], v[112:127]
    s_nop 0
    s_nop 0
    s_nop 0
    s_nop 0
    s_nop 0
    s_nop 0
    v_mfma_f32_32x32x16_bf16 v[112:127], a[248:251], v[48:51], v[112:127]
    s_nop 0
    s_nop 0
    s_nop 0
    s_nop 0
    v_cvt_pk_bf16_f32 v96, v96, v97
    v_cvt_pk_bf16_f32 v97, v98, v99
    v_mfma_f32_32x32x16_bf16 v[112:127], a[252:255], v[52:55], v[112:127]
    v_cvt_pk_bf16_f32 v98, v100, v101
    v_cvt_pk_bf16_f32 v99, v102, v103
    v_pk_max_i16 v96, v96, 0
    v_pk_max_i16 v97, v97, 0
    s_nop 0
    v_pk_max_i16 v98, v98, 0
    v_pk_max_i16 v99, v99, 0
    s_cmp_eq_u32 s100, 0
    s_cbranch_scc1 L_stg_35
    global_store_dwordx4 v236, v[96:99], s[44:45] offset:-3072 nt
L_stb_36:
    v_cvt_pk_bf16_f32 v100, v104, v105
    v_cvt_pk_bf16_f32 v101, v106, v107
    v_cvt_pk_bf16_f32 v102, v108, v109
    v_cvt_pk_bf16_f32 v103, v110, v111
    v_pk_max_i16 v100, v100, 0
    v_pk_max_i16 v101, v101, 0
    v_pk_max_i16 v102, v102, 0
    v_pk_max_i16 v103, v103, 0
    s_cmp_eq_u32 s100, 0
    s_cbranch_scc1 L_stg_37
    global_store_dwordx4 v236, v[100:103], s[44:45] offset:-1024 nt
L_stb_38:
    v_cvt_pk_bf16_f32 v104, v112, v113
    v_cvt_pk_bf16_f32 v105, v114, v115
    v_cvt_pk_bf16_f32 v106, v116, v117
    v_cvt_pk_bf16_f32 v107, v118, v119
    v_pk_max_i16 v104, v104, 0
    v_pk_max_i16 v105, v105, 0
    v_pk_max_i16 v106, v106, 0
    v_pk_max_i16 v107, v107, 0
    s_cmp_eq_u32 s100, 0
    s_cbranch_scc1 L_stg_39
    global_store_dwordx4 v236, v[104:107], s[44:45] offset:1024 nt
L_stb_40:
    v_cvt_pk_bf16_f32 v108, v120, v121
    v_cvt_pk_bf16_f32 v109, v122, v123
    v_cvt_pk_bf16_f32 v110, v124, v125
    v_cvt_pk_bf16_f32 v111, v126, v127
    v_pk_max_i16 v108, v108, 0
    v_pk_max_i16 v109, v109, 0
    v_pk_max_i16 v110, v110, 0
    v_pk_max_i16 v111, v111, 0
    s_cmp_eq_u32 s100, 0
    s_cbranch_scc1 L_stg_41
    global_store_dwordx4 v236, v[108:111], s[44:45] offset:3072 nt
L_stb_42:
    s_waitcnt vmcnt(4)
L_g1j_5:
    v_sub_u32 v238, v238, v3
    v_cmp_lt_u32 vcc, 1, v238
    s_cbranch_vccnz L_p3re_43
L_p3ok_44:
    s_cmp_lg_u32 s46, 3
    s_cbranch_scc1 L_x3_45
    buffer_load_dwordx4 v[224:227], v252, s[36:39], s17 offen offset:0 sc1
    buffer_load_dwordx4 v[228:231], v252, s[36:39], s17 offen offset:2048 sc1
L_x3_45:
    buffer_load_dwordx4 a[64:67], v252, s[36:39], s18 offen offset:0 sc1
    buffer_load_dwordx4 a[68:71], v252, s[36:39], s18 offen offset:2048 sc1
    s_lshl_b32 s64, s13, 6
    s_lshl_b32 s65, s9, 15
    v_xor_b32 v239, s64, v250
    v_add_u32 v239, s65, v239
    s_lshl_b32 s64, s51, 13
    s_lshl_b32 s65, s46, 11
    s_add_u32 s64, s64, s65
    v_add_u32 v232, s64, v250
    v_add_u32 v233, s64, v251
    s_waitcnt lgkmcnt(0)
    v_mfma_f32_32x32x16_bf16 v[80:95], v[128:131], v[64:67], 0
    buffer_load_dwordx4 a[72:75], v252, s[36:39], s19 offen offset:0 sc1
    ds_read_b64_tr_b16 v[16:17], v232 offset:0
    ds_read_b64_tr_b16 v[18:19], v232 offset:1024
    v_mfma_f32_32x32x16_bf16 v[40:55], v[132:135], v[64:67], 0
    buffer_load_dwordx4 a[76:79], v252, s[36:39], s19 offen offset:2048 sc1
    ds_read_b64_tr_b16 v[20:21], v233 offset:0
    ds_read_b64_tr_b16 v[22:23], v233 offset:1024
    v_mfma_f32_32x32x16_bf16 v[80:95], v[136:139], v[68:71], v[80:95]
    buffer_load_dwordx4 a[80:83], v252, s[36:39], s20 offen offset:0 sc1
    ds_read_b64_tr_b16 v[56:57], v239 offset:0
    ds_read_b64_tr_b16 v[58:59], v239 offset:1024
    v_mfma_f32_32x32x16_bf16 v[40:55], v[140:143], v[68:71], v[40:55]
    buffer_load_dwordx4 a[84:87], v252, s[36:39], s20 offen offset:2048 sc1
    ds_read_b64_tr_b16 v[60:61], v239 offset:2048
    ds_read_b64_tr_b16 v[62:63], v239 offset:3072
    s_cmp_eq_u32 s46, 3
    s_cbranch_scc1 L_own_46
    v_mfma_f32_32x32x16_bf16 v[80:95], v[144:147], v[72:75], v[80:95]
    v_mfma_f32_32x32x16_bf16 v[40:55], v[148:151], v[72:75], v[40:55]
    v_mfma_f32_32x32x16_bf16 v[80:95], v[152:155], v[76:79], v[80:95]
    v_mfma_f32_32x32x16_bf16 v[40:55], v[156:159], v[76:79], v[40:55]
L_own_46:
    v_mfma_f32_32x32x16_bf16 v[112:127], v[128:131], v[96:99], 0
    buffer_load_dwordx4 a[88:91], v252, s[36:39], s21 offen offset:0 sc1
    ds_read_b64_tr_b16 v[24:25], v239 offset:4096
    ds_read_b64_tr_b16 v[26:27], v239 offset:5120
    v_mfma_f32_32x32x16_bf16 v[64:79], v[132:135], v[96:99], 0
    buffer_load_dwordx4 a[92:95], v252, s[36:39], s21 offen offset:2048 sc1
    ds_read_b64_tr_b16 v[28:29], v239 offset:6144
    ds_read_b64_tr_b16 v[30:31], v239 offset:7168
    v_mfma_f32_32x32x16_bf16 v[112:127], v[136:139], v[100:103], v[112:127]
    buffer_load_dwordx4 a[96:99], v252, s[36:39], s22 offen offset:0 sc1
    ds_read_b64_tr_b16 v[12:13], v239 offset:8192
    ds_read_b64_tr_b16 v[14:15], v239 offset:9216
    v_mfma_f32_32x32x16_bf16 v[64:79], v[140:143], v[100:103], v[64:79]
    buffer_load_dwordx4 a[100:103], v252, s[36:39], s22 offen offset:2048 sc1
    s_cmp_eq_u32 s46, 3
    s_cbranch_scc1 L_own_47
    v_mfma_f32_32x32x16_bf16 v[112:127], v[144:147], v[104:107], v[112:127]
    v_mfma_f32_32x32x16_bf16 v[64:79], v[148:151], v[104:107], v[64:79]
    v_mfma_f32_32x32x16_bf16 v[112:127], v[152:155], v[108:111], v[112:127]
    v_mfma_f32_32x32x16_bf16 v[64:79], v[156:159], v[108:111], v[64:79]
L_own_47:
    s_waitcnt lgkmcnt(8)
    v_mfma_f32_32x32x16_bf16 v[96:111], v[56:59], v[56:59], 0
    s_nop 0
    ds_read_b64_tr_b16 v[4:5], v239 offset:10240
    ds_read_b64_tr_b16 v[6:7], v239 offset:11264
    s_add_u32 m0, s60, 0
    s_lshl3_add_u32 s15, s28, s14
    buffer_load_dwordx4 v240, s[52:55], s15 offen offset:0  lds
    s_waitcnt lgkmcnt(8)
    v_mfma_f32_32x32x16_bf16 v[96:111], v[60:63], v[60:63], v[96:111]
    ds_read_b64_tr_b16 v[56:57], v239 offset:12288
    ds_read_b64_tr_b16 v[58:59], v239 offset:13312
    s_nop 0
    buffer_load_dwordx4 v241, s[52:55], s15 offen offset:1024  lds
    s_waitcnt lgkmcnt(8)
    v_mfma_f32_32x32x16_bf16 v[96:111], v[24:27], v[24:27], v[96:111]
    ds_read_b64_tr_b16 v[60:61], v239 offset:14336
    ds_read_b64_tr_b16 v[62:63], v239 offset:15360
    s_waitcnt lgkmcnt(8)
    v_mfma_f32_32x32x16_bf16 v[96:111], v[28:31], v[28:31], v[96:111]
    ds_read_b64_tr_b16 v[24:25], v239 offset:16384
    ds_read_b64_tr_b16 v[26:27], v239 offset:17408
    buffer_load_dwordx4 v242, s[52:55], s15 offen offset:2048  lds
    s_waitcnt lgkmcnt(8)
    v_mfma_f32_32x32x16_bf16 v[96:111], v[12:15], v[12:15], v[96:111]
    ds_read_b64_tr_b16 v[28:29], v239 offset:18432
    ds_read_b64_tr_b16 v[30:31], v239 offset:19456
    buffer_load_dwordx4 v243, s[52:55], s15 offen offset:3072  lds
    s_waitcnt lgkmcnt(8)
    v_mfma_f32_32x32x16_bf16 v[96:111], v[4:7], v[4:7], v[96:111]
    ds_read_b64_tr_b16 v[12:13], v239 offset:20480
    ds_read_b64_tr_b16 v[14:15], v239 offset:21504
    s_waitcnt vmcnt(14)
    s_cmp_eq_u32 s100, 0
    s_mov_b64 exec, 1
    s_cbranch_scc1 L_stg_48
    global_store_dword v2, v237, s[44:45]
L_stb_49:
    s_mov_b64 exec, -1
    s_waitcnt lgkmcnt(8)
    v_mfma_f32_32x32x16_bf16 v[96:111], v[56:59], v[56:59], v[96:111]
    ds_read_b64_tr_b16 v[4:5], v239 offset:22528
    ds_read_b64_tr_b16 v[6:7], v239 offset:23552
    s_add_u32 m0, s60, 4096
    s_lshl3_add_u32 s15, s29, s14
    buffer_load_dwordx4 v240, s[52:55], s15 offen offset:0  lds
    s_waitcnt lgkmcnt(8)
    v_mfma_f32_32x32x16_bf16 v[96:111], v[60:63], v[60:63], v[96:111]
    ds_read_b64_tr_b16 v[56:57], v239 offset:24576
    ds_read_b64_tr_b16 v[58:59], v239 offset:25600
    buffer_load_dwordx4 v241, s[52:55], s15 offen offset:1024  lds
    s_waitcnt lgkmcnt(8)
    s_nop 0
    v_mfma_f32_32x32x16_bf16 v[96:111], v[24:27], v[24:27], v[96:111]
    ds_read_b64_tr_b16 v[60:61], v239 offset:26624
    ds_read_b64_tr_b16 v[62:63], v239 offset:27648
    s_waitcnt lgkmcnt(8)
    v_mfma_f32_32x32x16_bf16 v[96:111], v[28:31], v[28:31], v[96:111]
    ds_read_b64_tr_b16 v[24:25], v239 offset:28672
    ds_read_b64_tr_b16 v[26:27], v239 offset:29696
    buffer_load_dwordx4 v242, s[52:55], s15 offen offset:2048  lds
    s_waitcnt lgkmcnt(8)
    v_mfma_f32_32x32x16_bf16 v[96:111], v[12:15], v[12:15], v[96:111]
    ds_read_b64_tr_b16 v[28:29], v239 offset:30720
    ds_read_b64_tr_b16 v[30:31], v239 offset:31744
    buffer_load_dwordx4 v243, s[52:55], s15 offen offset:3072  lds
    s_waitcnt lgkmcnt(8)
    v_mfma_f32_32x32x16_bf16 v[96:111], v[4:7], v[4:7], v[96:111]
    s_waitcnt lgkmcnt(6)
    v_mfma_f32_32x32x16_bf16 v[96:111], v[56:59], v[56:59], v[96:111]
    s_waitcnt lgkmcnt(4)
    s_nop 0
    v_mfma_f32_32x32x16_bf16 v[96:111], v[60:63], v[60:63], v[96:111]
    s_waitcnt lgkmcnt(2)
    v_mfma_f32_32x32x16_bf16 v[96:111], v[24:27], v[24:27], v[96:111]
    s_waitcnt lgkmcnt(0)
    v_mfma_f32_32x32x16_bf16 v[96:111], v[28:31], v[28:31], v[96:111]
    s_waitcnt vmcnt(17)
    s_cmp_lg_u32 s46, 3
    s_cbranch_scc1 L_x3_50
    v_mfma_f32_32x32x16_bf16 v[80:95], v[144:147], v[224:227], v[80:95]
    v_mfma_f32_32x32x16_bf16 v[40:55], v[148:151], v[224:227], v[40:55]
    s_nop 0
    v_mfma_f32_32x32x16_bf16 v[80:95], v[152:155], v[228:231], v[80:95]
    v_mfma_f32_32x32x16_bf16 v[40:55], v[156:159], v[228:231], v[40:55]
L_x3_50:
    v_mfma_f32_32x32x16_bf16 v[80:95], v[160:163], a[64:67], v[80:95]
    buffer_load_dwordx4 a[104:107], v252, s[36:39], s23 offen offset:0 sc1
    ds_read_b64_tr_b16 a[32:33], v246 offset:0
    ds_read_b64_tr_b16 a[34:35], v246 offset:1024
    v_mfma_f32_32x32x16_bf16 v[40:55], v[164:167], a[64:67], v[40:55]
    ds_read_b64_tr_b16 a[160:161], v247 offset:0
    s_waitcnt vmcnt(17)
    v_mfma_f32_32x32x16_bf16 v[80:95], v[168:171], a[68:71], v[80:95]
    buffer_load_dwordx4 a[108:111], v252, s[36:39], s23 offen offset:2048 sc1
    ds_read_b64_tr_b16 a[162:163], v247 offset:1024
    ds_read_b64_tr_b16 a[36:37], v246 offset:2048
    v_mfma_f32_32x32x16_bf16 v[40:55], v[172:175], a[68:71], v[40:55]
    ds_read_b64_tr_b16 a[38:39], v246 offset:3072
    s_waitcnt vmcnt(17)
    v_mfma_f32_32x32x16_bf16 v[80:95], v[176:179], a[72:75], v[80:95]
    buffer_load_dwordx4 a[112:115], v252, s[36:39], s24 offen offset:0 sc1
    ds_read_b64_tr_b16 a[164:165], v247 offset:2048
    ds_read_b64_tr_b16 a[166:167], v247 offset:3072
    v_mfma_f32_32x32x16_bf16 v[40:55], v[180:183], a[72:75], v[40:55]
    ds_read_b64_tr_b16 a[40:41], v246 offset:4096
    s_waitcnt vmcnt(17)
    v_mfma_f32_32x32x16_bf16 v[80:95], v[184:187], a[76:79], v[80:95]
    buffer_load_dwordx4 a[116:119], v252, s[36:39], s24 offen offset:2048 sc1
    s_nop 0
    ds_read_b64_tr_b16 a[42:43], v246 offset:5120
    ds_read_b64_tr_b16 a[168:169], v247 offset:4096
    v_mfma_f32_32x32x16_bf16 v[40:55], v[188:191], a[76:79], v[40:55]
    ds_read_b64_tr_b16 a[170:171], v247 offset:5120
    s_waitcnt vmcnt(17)
    v_mfma_f32_32x32x16_bf16 v[80:95], v[192:195], a[80:83], v[80:95]
    buffer_load_dwordx4 a[120:123], v252, s[36:39], s25 offen offset:0 sc1
    ds_read_b64_tr_b16 a[44:45], v246 offset:6144
    s_nop 0
    ds_read_b64_tr_b16 a[46:47], v246 offset:7168
    v_mfma_f32_32x32x16_bf16 v[40:55], v[196:199], a[80:83], v[40:55]
    ds_read_b64_tr_b16 a[172:173], v247 offset:6144
    s_waitcnt vmcnt(17)
    v_mfma_f32_32x32x16_bf16 v[80:95], v[200:203], a[84:87], v[80:95]
    buffer_load_dwordx4 a[124:127], v252, s[36:39], s25 offen offset:2048 sc1
    ds_read_b64_tr_b16 a[174:175], v247 offset:7168
    v_mfma_f32_32x32x16_bf16 v[40:55], v[204:207], a[84:87], v[40:55]
    s_nop 0
    s_mov_b32 s70, 0xffff0000
    s_mov_b32 s71, 0xffff0000
    v_cndmask_b32 v96, v96, v104, s[70:71]
    v_cndmask_b32 v97, v97, v105, s[70:71]
    v_cndmask_b32 v98, v98, v106, s[70:71]
    v_cndmask_b32 v99, v99, v107, s[70:71]
    s_waitcnt vmcnt(17)
    global_load_dword v238, v35, s[44:45] sc1
    s_nop 0
    v_mfma_f32_32x32x16_bf16 v[80:95], v[208:211], a[88:91], v[80:95]
    buffer_load_dwordx4 a[192:195], v252, s[36:39], s26 offen offset:0 sc1
    v_mfma_f32_32x32x16_bf16 v[40:55], v[212:215], a[88:91], v[40:55]
    v_cndmask_b32 v100, v100, v108, s[70:71]
    v_cndmask_b32 v101, v101, v109, s[70:71]
    v_cndmask_b32 v102, v102, v110, s[70:71]
    v_cndmask_b32 v103, v103, v111, s[70:71]
    s_waitcnt vmcnt(18)
    s_nop 0
    v_mfma_f32_32x32x16_bf16 v[80:95], v[216:219], a[92:95], v[80:95]
    buffer_load_dwordx4 a[196:199], v252, s[36:39], s26 offen offset:2048 sc1
    v_mfma_f32_32x32x16_bf16 v[40:55], v[220:223], a[92:95], v[40:55]
    s_mov_b32 s70, 0xff00ff00
    s_mov_b32 s71, 0xff00ff00
    v_cndmask_b32 v96, v96, v100, s[70:71]
    v_cndmask_b32 v97, v97, v101, s[70:71]
    v_cndmask_b32 v98, v98, v102, s[70:71]
    v_cndmask_b32 v99, v99, v103, s[70:71]
    s_waitcnt vmcnt(18)
    v_mfma_f32_32x32x16_bf16 v[80:95], a[0:3], a[96:99], v[80:95]
    buffer_load_dwordx4 a[200:203], v252, s[36:39], s27 offen offset:0 sc1
    v_mfma_f32_32x32x16_bf16 v[40:55], a[128:131], a[96:99], v[40:55]
    s_mov_b32 s70, 0xcccccccc
    s_mov_b32 s71, 0xcccccccc
    v_cndmask_b32 v96, v96, v98, s[70:71]
    s_nop 0
    v_cndmask_b32 v97, v97, v99, s[70:71]
    s_waitcnt vmcnt(18)
    v_mfma_f32_32x32x16_bf16 v[80:95], a[4:7], a[100:103], v[80:95]
    buffer_load_dwordx4 a[204:207], v252, s[36:39], s27 offen offset:2048 sc1
    v_mfma_f32_32x32x16_bf16 v[40:55], a[132:135], a[100:103], v[40:55]
    s_mov_b32 s70, 0xaaaaaaaa
    s_mov_b32 s71, 0xaaaaaaaa
    v_cndmask_b32 v96, v96, v97, s[70:71]
    s_waitcnt vmcnt(10)
    v_mfma_f32_32x32x16_bf16 v[80:95], a[8:11], a[104:107], v[80:95]
    buffer_load_dwordx4 a[208:211], v252, s[36:39], s28 offen offset:0 sc1
    v_mfma_f32_32x32x16_bf16 v[40:55], a[136:139], a[104:107], v[40:55]
    v_and_b32 v234, 31, v0
    v_lshlrev_b32 v234, 2, v234
    v_add_u32 v235, s60, v234
    s_waitcnt vmcnt(10)
    v_mfma_f32_32x32x16_bf16 v[80:95], a[12:15], a[108:111], v[80:95]
    buffer_load_dwordx4 a[212:215], v252, s[36:39], s28 offen offset:2048 sc1
    v_mfma_f32_32x32x16_bf16 v[40:55], a[140:143], a[108:111], v[40:55]
    ds_read_b64_tr_b16 a[48:49], v244 offset:0
    ds_read_b64_tr_b16 a[50:51], v244 offset:1024
    s_waitcnt vmcnt(10)
    v_mfma_f32_32x32x16_bf16 v[80:95], a[16:19], a[112:115], v[80:95]
    buffer_load_dwordx4 a[216:219], v252, s[36:39], s29 offen offset:0 sc1
    v_mfma_f32_32x32x16_bf16 v[40:55], a[144:147], a[112:115], v[40:55]
    ds_read_b64_tr_b16 a[176:177], v245 offset:0
    ds_read_b64_tr_b16 a[178:179], v245 offset:1024
    s_nop 0
    ds_read_b64_tr_b16 a[52:53], v244 offset:2048
    s_waitcnt vmcnt(10)
    v_mfma_f32_32x32x16_bf16 v[80:95], a[20:23], a[116:119], v[80:95]
    buffer_load_dwordx4 a[220:223], v252, s[36:39], s29 offen offset:2048 sc1
    v_mfma_f32_32x32x16_bf16 v[40:55], a[148:151], a[116:119], v[40:55]
    ds_read_b64_tr_b16 a[54:55], v244 offset:3072
    ds_read_b64_tr_b16 a[180:181], v245 offset:2048
    ds_read_b64_tr_b16 a[182:183], v245 offset:3072
    s_waitcnt vmcnt(8)
    v_cmp_ne_u32 vcc, v238, v237
    s_cbranch_vccnz L_p3re_51
L_p3ok_52:
    s_cmp_lg_u32 s46, 3
    s_cbranch_scc1 L_x3_53
    buffer_load_dwordx4 v[224:227], v252, s[36:39], s17 offen offset:1024 sc1
    buffer_load_dwordx4 v[228:231], v252, s[36:39], s17 offen offset:3072 sc1
L_x3_53:
    v_mfma_f32_32x32x16_bf16 v[80:95], a[24:27], a[120:123], v[80:95]
    buffer_load_dwordx4 a[224:227], v252, s[36:39], s18 offen offset:1024 sc1
    v_mfma_f32_32x32x16_bf16 v[40:55], a[152:155], a[120:123], v[40:55]
    ds_read_b64_tr_b16 a[56:57], v244 offset:4096
    ds_read_b64_tr_b16 a[58:59], v244 offset:5120
    ds_read_b64_tr_b16 a[184:185], v245 offset:4096
    v_mfma_f32_32x32x16_bf16 v[80:95], a[28:31], a[124:127], v[80:95]
    buffer_load_dwordx4 a[228:231], v252, s[36:39], s18 offen offset:3072 sc1
    v_mfma_f32_32x32x16_bf16 v[40:55], a[156:159], a[124:127], v[40:55]
    ds_read_b64_tr_b16 a[186:187], v245 offset:5120
    ds_read_b64_tr_b16 a[60:61], v244 offset:6144
    ds_read_b64_tr_b16 a[62:63], v244 offset:7168
    s_waitcnt vmcnt(9)
    s_waitcnt lgkmcnt(14)
    v_mfma_f32_32x32x16_bf16 v[80:95], a[32:35], a[192:195], v[80:95]
    buffer_load_dwordx4 a[232:235], v252, s[36:39], s19 offen offset:1024 sc1
    v_mfma_f32_32x32x16_bf16 v[40:55], a[160:163], a[192:195], v[40:55]
    ds_read_b64_tr_b16 a[188:189], v245 offset:6144
    ds_read_b64_tr_b16 a[190:191], v245 offset:7168
    s_mov_b32 exec_lo, 0x0f0f0f0f
    s_mov_b32 exec_hi, 0xf0f0f0f0
    ds_write_b32 v235, v96 offset:12288
    s_mov_b64 exec, -1
    s_waitcnt vmcnt(9)
    v_mfma_f32_32x32x16_bf16 v[80:95], a[36:39], a[196:199], v[80:95]
    buffer_load_dwordx4 a[236:239], v252, s[36:39], s19 offen offset:3072 sc1
    v_mfma_f32_32x32x16_bf16 v[40:55], a[164:167], a[196:199], v[40:55]
    v_bfe_u32 v235, v0, 5, 1
    v_lshl_add_u32 v234, v235, 14, v234
    v_add_u32 v234, 110592, v234
    s_mov_b32 s70, 0
    s_mov_b32 s71, -1
    s_waitcnt vmcnt(9)
    v_mfma_f32_32x32x16_bf16 v[80:95], a[40:43], a[200:203], v[80:95]
    buffer_load_dwordx4 a[240:243], v252, s[36:39], s20 offen offset:1024 sc1
    v_mfma_f32_32x32x16_bf16 v[40:55], a[168:171], a[200:203], v[40:55]
    v_cndmask_b32 v8, v32, v33, s[70:71]
    v_add_u32_e64 v24, s60, v252
    s_waitcnt vmcnt(9)
    v_mfma_f32_32x32x16_bf16 v[80:95], a[44:47], a[204:207], v[80:95]
    buffer_load_dwordx4 a[244:247], v252, s[36:39], s20 offen offset:3072 sc1
    v_mfma_f32_32x32x16_bf16 v[40:55], a[172:175], a[204:207], v[40:55]
    s_xor_b32 s70, s46, 1
    s_lshl_b32 s70, s70, 14
    s_add_u32 s70, s70, 98304
    v_add_u32_e64 v25, s70, v252
    s_waitcnt vmcnt(9)
    s_waitcnt lgkmcnt(1)
    v_mfma_f32_32x32x16_bf16 v[80:95], a[48:51], a[208:211], v[80:95]
    buffer_load_dwordx4 a[248:251], v252, s[36:39], s21 offen offset:1024 sc1
    v_mfma_f32_32x32x16_bf16 v[40:55], a[176:179], a[208:211], v[40:55]
    s_xor_b32 s70, s46, 2
    s_lshl_b32 s70, s70, 14
    s_add_u32 s70, s70, 100352
    v_add_u32 v26, s70, v252
    s_waitcnt vmcnt(9)
    v_mfma_f32_32x32x16_bf16 v[80:95], a[52:55], a[212:215], v[80:95]
    buffer_load_dwordx4 a[252:255], v252, s[36:39], s21 offen offset:3072 sc1
    v_mfma_f32_32x32x16_bf16 v[40:55], a[180:183], a[212:215], v[40:55]
    s_xor_b32 s70, s46, 3
    s_lshl_b32 s70, s70, 14
    s_add_u32 s70, s70, 102400
    v_add_u32 v27, s70, v252
    s_waitcnt vmcnt(9)
    v_mfma_f32_32x32x16_bf16 v[80:95], a[56:59], a[216:219], v[80:95]
    buffer_load_dwordx4 a[64:67], v252, s[36:39], s22 offen offset:1024 sc1
    v_mfma_f32_32x32x16_bf16 v[40:55], a[184:187], a[216:219], v[40:55]
    v_and_b32 v30, 31, v0
    v_mul_u32_u24 v30, 144, v30
    v_lshl_add_u32 v30, v235, 3, v30
    s_lshl_b32 s70, s46, 5
    v_add_u32 v30, s70, v30
    s_waitcnt vmcnt(9)
    v_mfma_f32_32x32x16_bf16 v[80:95], a[60:63], a[220:223], v[80:95]
    buffer_load_dwordx4 a[68:71], v252, s[36:39], s22 offen offset:3072 sc1
    v_mfma_f32_32x32x16_bf16 v[40:55], a[188:191], a[220:223], v[40:55]
    s_lshl_b32 s70, s46, 4
    v_add_u32 v28, s70, v248
    v_and_b32 v29, 7, v0
    v_mul_u32_u24 v31, 144, v28
    v_lshl_add_u32 v31, v29, 4, v31
    s_waitcnt vmcnt(9)
    s_cmp_lg_u32 s46, 3
    s_cbranch_scc1 L_x3_54
    v_mfma_f32_32x32x16_bf16 v[112:127], v[144:147], v[224:227], v[112:127]
    v_mfma_f32_32x32x16_bf16 v[64:79], v[148:151], v[224:227], v[64:79]
    v_mfma_f32_32x32x16_bf16 v[112:127], v[152:155], v[228:231], v[112:127]
    v_mfma_f32_32x32x16_bf16 v[64:79], v[156:159], v[228:231], v[64:79]
L_x3_54:
    v_mfma_f32_32x32x16_bf16 v[112:127], v[160:163], a[224:227], v[112:127]
    buffer_load_dwordx4 a[72:75], v252, s[36:39], s23 offen offset:1024 sc1
    v_mfma_f32_32x32x16_bf16 v[64:79], v[164:167], a[224:227], v[64:79]
    s_lshl_b32 s70, s50, 16
    s_lshl_b32 s71, s51, 7
    s_add_u32 s70, s70, s71
    v_lshl_add_u32 v28, v28, 10, s70
    v_lshl_add_u32 v28, v29, 4, v28
    v_add_u32 v29, 8192, v28
    s_waitcnt vmcnt(9)
    v_mfma_f32_32x32x16_bf16 v[112:127], v[168:171], a[228:231], v[112:127]
    buffer_load_dwordx4 a[76:79], v252, s[36:39], s23 offen offset:3072 sc1
    v_mfma_f32_32x32x16_bf16 v[64:79], v[172:175], a[228:231], v[64:79]
    v_lshlrev_b32 v128, 16, v16
    v_and_b32 v129, 0xffff0000, v16
    v_lshlrev_b32 v130, 16, v17
    v_and_b32 v131, 0xffff0000, v17
    s_waitcnt vmcnt(9)
    v_mfma_f32_32x32x16_bf16 v[112:127], v[176:179], a[232:235], v[112:127]
    buffer_load_dwordx4 a[80:83], v252, s[36:39], s24 offen offset:1024 sc1
    v_mfma_f32_32x32x16_bf16 v[64:79], v[180:183], a[232:235], v[64:79]
    v_lshlrev_b32 v132, 16, v18
    v_and_b32 v133, 0xffff0000, v18
    v_lshlrev_b32 v134, 16, v19
    v_and_b32 v135, 0xffff0000, v19
    s_waitcnt vmcnt(9)
    v_mfma_f32_32x32x16_bf16 v[112:127], v[184:187], a[236:239], v[112:127]
    buffer_load_dwordx4 a[84:87], v252, s[36:39], s24 offen offset:3072 sc1
    v_mfma_f32_32x32x16_bf16 v[64:79], v[188:191], a[236:239], v[64:79]
    v_lshlrev_b32 v136, 16, v20
    v_and_b32 v137, 0xffff0000, v20
    v_lshlrev_b32 v138, 16, v21
    v_and_b32 v139, 0xffff0000, v21
    s_waitcnt vmcnt(9)
    v_mfma_f32_32x32x16_bf16 v[112:127], v[192:195], a[240:243], v[112:127]
    buffer_load_dwordx4 a[88:91], v252, s[36:39], s25 offen offset:1024 sc1
    v_mfma_f32_32x32x16_bf16 v[64:79], v[196:199], a[240:243], v[64:79]
    v_lshlrev_b32 v140, 16, v22
    v_and_b32 v141, 0xffff0000, v22
    v_lshlrev_b32 v142, 16, v23
    v_and_b32 v143, 0xffff0000, v23
    s_waitcnt vmcnt(9)
    v_mfma_f32_32x32x16_bf16 v[112:127], v[200:203], a[244:247], v[112:127]
    buffer_load_dwordx4 a[92:95], v252, s[36:39], s25 offen offset:3072 sc1
    v_mfma_f32_32x32x16_bf16 v[64:79], v[204:207], a[244:247], v[64:79]
    s_waitcnt vmcnt(9)
    v_mfma_f32_32x32x16_bf16 v[112:127], v[208:211], a[248:251], v[112:127]
    buffer_load_dwordx4 a[96:99], v252, s[36:39], s26 offen offset:1024 sc1
    v_mfma_f32_32x32x16_bf16 v[64:79], v[212:215], a[248:251], v[64:79]
    s_waitcnt vmcnt(9)
    v_mfma_f32_32x32x16_bf16 v[112:127], v[216:219], a[252:255], v[112:127]
    buffer_load_dwordx4 a[100:103], v252, s[36:39], s26 offen offset:3072 sc1
    v_mfma_f32_32x32x16_bf16 v[64:79], v[220:223], a[252:255], v[64:79]
    ds_write_b128 v24, v[88:91] offset:0
    s_waitcnt vmcnt(9)
    v_mfma_f32_32x32x16_bf16 v[112:127], a[0:3], a[64:67], v[112:127]
    buffer_load_dwordx4 a[104:107], v252, s[36:39], s27 offen offset:1024 sc1
    v_mfma_f32_32x32x16_bf16 v[64:79], a[128:131], a[64:67], v[64:79]
    ds_write_b128 v24, v[92:95] offset:1024
    s_waitcnt vmcnt(9)
    v_mfma_f32_32x32x16_bf16 v[112:127], a[4:7], a[68:71], v[112:127]
    buffer_load_dwordx4 a[108:111], v252, s[36:39], s27 offen offset:3072 sc1
    v_mfma_f32_32x32x16_bf16 v[64:79], a[132:135], a[68:71], v[64:79]
    ds_write_b128 v24, v[40:43] offset:2048
    s_waitcnt vmcnt(9)
    v_mfma_f32_32x32x16_bf16 v[112:127], a[8:11], a[72:75], v[112:127]
    buffer_load_dwordx4 a[112:115], v252, s[36:39], s28 offen offset:1024 sc1
    v_mfma_f32_32x32x16_bf16 v[64:79], a[136:139], a[72:75], v[64:79]
    ds_write_b128 v24, v[44:47] offset:3072
    s_waitcnt vmcnt(9)
    v_mfma_f32_32x32x16_bf16 v[112:127], a[12:15], a[76:79], v[112:127]
    buffer_load_dwordx4 a[116:119], v252, s[36:39], s28 offen offset:3072 sc1
    v_mfma_f32_32x32x16_bf16 v[64:79], a[140:143], a[76:79], v[64:79]
    ds_write_b128 v24, v[48:51] offset:4096
    s_waitcnt vmcnt(9)
    v_mfma_f32_32x32x16_bf16 v[112:127], a[16:19], a[80:83], v[112:127]
    buffer_load_dwordx4 a[120:123], v252, s[36:39], s29 offen offset:1024 sc1
    v_mfma_f32_32x32x16_bf16 v[64:79], a[144:147], a[80:83], v[64:79]
    s_nop 0
    ds_write_b128 v24, v[52:55] offset:5120
    s_waitcnt vmcnt(9)
    v_mfma_f32_32x32x16_bf16 v[112:127], a[20:23], a[84:87], v[112:127]
    buffer_load_dwordx4 a[124:127], v252, s[36:39], s29 offen offset:3072 sc1
    v_mfma_f32_32x32x16_bf16 v[64:79], a[148:151], a[84:87], v[64:79]
    s_waitcnt vmcnt(9)
    v_mfma_f32_32x32x16_bf16 v[112:127], a[24:27], a[88:91], v[112:127]
    v_mfma_f32_32x32x16_bf16 v[64:79], a[152:155], a[88:91], v[64:79]
    s_waitcnt vmcnt(8)
    s_nop 0
    v_mfma_f32_32x32x16_bf16 v[112:127], a[28:31], a[92:95], v[112:127]
    v_mfma_f32_32x32x16_bf16 v[64:79], a[156:159], a[92:95], v[64:79]
    s_waitcnt vmcnt(7)
    v_mfma_f32_32x32x16_bf16 v[112:127], a[32:35], a[96:99], v[112:127]
    v_mfma_f32_32x32x16_bf16 v[64:79], a[160:163], a[96:99], v[64:79]
    s_waitcnt vmcnt(6)
    v_mfma_f32_32x32x16_bf16 v[112:127], a[36:39], a[100:103], v[112:127]
    v_mfma_f32_32x32x16_bf16 v[64:79], a[164:167], a[100:103], v[64:79]
    s_waitcnt vmcnt(5)
    s_nop 0
    v_mfma_f32_32x32x16_bf16 v[112:127], a[40:43], a[104:107], v[112:127]
    v_mfma_f32_32x32x16_bf16 v[64:79], a[168:171], a[104:107], v[64:79]
    s_waitcnt vmcnt(4)
    v_mfma_f32_32x32x16_bf16 v[112:127], a[44:47], a[108:111], v[112:127]
    v_mfma_f32_32x32x16_bf16 v[64:79], a[172:175], a[108:111], v[64:79]
    s_waitcnt vmcnt(3)
    v_mfma_f32_32x32x16_bf16 v[112:127], a[48:51], a[112:115], v[112:127]
    v_mfma_f32_32x32x16_bf16 v[64:79], a[176:179], a[112:115], v[64:79]
    s_waitcnt vmcnt(2)
    s_nop 0
    v_mfma_f32_32x32x16_bf16 v[112:127], a[52:55], a[116:119], v[112:127]
    v_mfma_f32_32x32x16_bf16 v[64:79], a[180:183], a[116:119], v[64:79]
    s_waitcnt vmcnt(1)
    v_mfma_f32_32x32x16_bf16 v[112:127], a[56:59], a[120:123], v[112:127]
    v_mfma_f32_32x32x16_bf16 v[64:79], a[184:187], a[120:123], v[64:79]
    s_waitcnt vmcnt(0)
    v_mfma_f32_32x32x16_bf16 v[64:79], a[188:191], a[124:127], v[64:79]
    v_mfma_f32_32x32x16_bf16 v[112:127], a[60:63], a[124:127], v[112:127]
    s_nop 10
    s_nop 0
    ds_write_b128 v24, v[64:67] offset:8192
    ds_write_b128 v24, v[68:71] offset:9216
    ds_write_b128 v24, v[72:75] offset:10240
    ds_write_b128 v24, v[76:79] offset:11264
    ds_write_b128 v24, v[120:123] offset:6144
    ds_write_b128 v24, v[124:127] offset:7168
    s_waitcnt lgkmcnt(0)
    s_barrier
    ds_read2st64_b32 v[12:13], v234 offset0:0 offset1:128
    ds_read_b128 v[144:147], v25 offset:0
    ds_read_b128 v[160:163], v26 offset:0
    ds_read_b128 v[176:179], v27 offset:0
    ds_read_b128 v[148:151], v25 offset:1024
    ds_read_b128 v[164:167], v26 offset:1024
    ds_read_b128 v[180:183], v27 offset:1024
    ds_read_b128 v[152:155], v25 offset:6144
    ds_read_b128 v[168:171], v26 offset:6144
    ds_read_b128 v[184:187], v27 offset:6144
    ds_read_b128 v[156:159], v25 offset:7168
    ds_read_b128 v[172:175], v26 offset:7168
    ds_read_b128 v[188:191], v27 offset:7168
    s_waitcnt lgkmcnt(12)
    v_add_f32 v12, v12, v13
    v_mul_f32 v12, 0x3b000000, v12
    v_fma_f32 v12, -v8, v8, v12
    v_max_f32_e64 v12, 0, v12
    v_cvt_pk_bf16_f32 v8, v8, v12
    v_and_b32 v13, 0xffff0000, v8
    v_add_f32 v13, 0x3727c5ac, v13
    v_cvt_pk_bf16_f32 v13, v13, v13
    v_and_b32 v13, 0xffff0000, v13
    v_sqrt_f32_e64 v13, v13
    v_mov_b32 v14, 0xffff
    v_cvt_pk_bf16_f32 v13, v13, v13
    v_bfi_b32 v8, v14, v8, v13
    v_and_b32 v8, 0xffff0000, v8
    v_rcp_f32 v8, v8
    s_nop 0
    v_mov_b32 v9, v8
    s_nop 1
    v_permlane32_swap_b32 v8, v9
    s_waitcnt lgkmcnt(9)
    v_pk_add_f32 v[144:145], v[144:145], v[160:161]
    v_pk_add_f32 v[146:147], v[146:147], v[162:163]
    v_pk_add_f32 v[80:81], v[80:81], v[176:177]
    v_pk_add_f32 v[82:83], v[82:83], v[178:179]
    v_pk_add_f32 v[80:81], v[80:81], v[144:145]
    v_pk_add_f32 v[82:83], v[82:83], v[146:147]
    v_pk_fma_f32 v[80:81], v[80:81], v[8:9], v[128:129] op_sel:[0,0,0] op_sel_hi:[1,0,1]
    v_pk_fma_f32 v[82:83], v[82:83], v[8:9], v[130:131] op_sel:[0,0,0] op_sel_hi:[1,0,1]
    v_cvt_pk_bf16_f32 v16, v80, v81
    v_cvt_pk_bf16_f32 v17, v82, v83
    s_waitcnt lgkmcnt(6)
    s_nop 0
    v_pk_add_f32 v[148:149], v[148:149], v[164:165]
    v_pk_add_f32 v[150:151], v[150:151], v[166:167]
    v_pk_add_f32 v[84:85], v[84:85], v[180:181]
    v_pk_add_f32 v[86:87], v[86:87], v[182:183]
    v_pk_add_f32 v[84:85], v[84:85], v[148:149]
    v_pk_add_f32 v[86:87], v[86:87], v[150:151]
    v_pk_fma_f32 v[84:85], v[84:85], v[8:9], v[132:133] op_sel:[0,0,0] op_sel_hi:[1,0,1]
    v_pk_fma_f32 v[86:87], v[86:87], v[8:9], v[134:135] op_sel:[0,0,0] op_sel_hi:[1,0,1]
    v_cvt_pk_bf16_f32 v18, v84, v85
    v_cvt_pk_bf16_f32 v19, v86, v87
    s_waitcnt lgkmcnt(3)
    v_pk_add_f32 v[152:153], v[152:153], v[168:169]
    v_pk_add_f32 v[154:155], v[154:155], v[170:171]
    v_pk_add_f32 v[112:113], v[112:113], v[184:185]
    v_pk_add_f32 v[114:115], v[114:115], v[186:187]
    v_pk_add_f32 v[112:113], v[112:113], v[152:153]
    s_nop 0
    v_pk_add_f32 v[114:115], v[114:115], v[154:155]
    v_pk_fma_f32 v[112:113], v[112:113], v[8:9], v[136:137] op_sel:[0,1,0] op_sel_hi:[1,1,1]
    v_pk_fma_f32 v[114:115], v[114:115], v[8:9], v[138:139] op_sel:[0,1,0] op_sel_hi:[1,1,1]
    v_cvt_pk_bf16_f32 v20, v112, v113
    v_cvt_pk_bf16_f32 v21, v114, v115
    s_waitcnt lgkmcnt(0)
    v_pk_add_f32 v[156:157], v[156:157], v[172:173]
    v_pk_add_f32 v[158:159], v[158:159], v[174:175]
    s_nop 0
    v_pk_add_f32 v[116:117], v[116:117], v[188:189]
    v_pk_add_f32 v[118:119], v[118:119], v[190:191]
    v_pk_add_f32 v[116:117], v[116:117], v[156:157]
    v_pk_add_f32 v[118:119], v[118:119], v[158:159]
    v_pk_fma_f32 v[116:117], v[116:117], v[8:9], v[140:141] op_sel:[0,1,0] op_sel_hi:[1,1,1]
    v_pk_fma_f32 v[118:119], v[118:119], v[8:9], v[142:143] op_sel:[0,1,0] op_sel_hi:[1,1,1]
    v_cvt_pk_bf16_f32 v22, v116, v117
    v_cvt_pk_bf16_f32 v23, v118, v119
    ds_write_b64 v30, v[16:17] offset:0
    ds_write_b64 v30, v[18:19] offset:16
    ds_write_b64 v30, v[20:21] offset:4608
    ds_write_b64 v30, v[22:23] offset:4624
    s_waitcnt lgkmcnt(0)
    s_barrier
    ds_read_b128 v[96:99], v31
    ds_read_b128 v[100:103], v31 offset:1152
    s_waitcnt lgkmcnt(1)
    s_nop 0
    global_store_dwordx4 v28, v[96:99], s[40:41] nt
    s_waitcnt lgkmcnt(0)
    global_store_dwordx4 v29, v[100:103], s[40:41] nt
L_END:
    s_endpgm
L_epoch_3:
    v_mov_b32 v1, 32768
    v_mov_b32_e64 v2, s4
    s_mov_b64 exec, 1
    global_store_dword v1, v2, s[44:45] offset:0 sc1
    s_mov_b64 exec, -1
    s_branch L_noepoch_4
L_g1r3_8:
    s_mov_b64 s[34:35], 0
    v_add_u32 v232, 65536, v232
    v_add_u32 v233, 65536, v233
    v_add_u32 v234, 65536, v234
    v_add_u32 v235, 65536, v235
    s_waitcnt vmcnt(0) lgkmcnt(0)
    s_barrier
    s_branch L_p2retry_11
L_stg_15:
    global_store_dwordx4 v236, v[64:67], s[44:45] offset:-4096 sc1
    s_branch L_stb_16
L_stg_17:
    global_store_dwordx4 v236, v[68:71], s[44:45] offset:-2048 sc1
    s_branch L_stb_18
L_stg_19:
    global_store_dword v2, v3, s[44:45] sc1
    s_branch L_stb_20
L_stg_21:
    global_store_dwordx4 v236, v[96:99], s[44:45] offset:-3072 sc1
    s_branch L_stb_22
L_stg_23:
    global_store_dwordx4 v236, v[100:103], s[44:45] offset:-1024 sc1
    s_branch L_stb_24
L_g1r_7:
    s_mov_b64 s[34:35], 0
    s_waitcnt vmcnt(0) lgkmcnt(0)
    s_barrier
    s_branch L_g1s_6
L_stg_25:
    global_store_dwordx4 v236, v[64:67], s[44:45] offset:-4096 sc1
    s_branch L_stb_26
L_stg_27:
    global_store_dwordx4 v236, v[68:71], s[44:45] offset:-2048 sc1
    s_branch L_stb_28
L_stg_29:
    global_store_dwordx4 v236, v[72:75], s[44:45] offset:0 sc1
    s_branch L_stb_30
L_stg_31:
    global_store_dwordx4 v236, v[76:79], s[44:45] offset:2048 sc1
    s_branch L_stb_32
L_stg_33:
    global_store_dword v2, v3, s[44:45] sc1
    s_branch L_stb_34
L_stg_35:
    global_store_dwordx4 v236, v[96:99], s[44:45] offset:-3072 sc1
    s_branch L_stb_36
L_stg_37:
    global_store_dwordx4 v236, v[100:103], s[44:45] offset:-1024 sc1
    s_branch L_stb_38
L_stg_39:
    global_store_dwordx4 v236, v[104:107], s[44:45] offset:1024 sc1
    s_branch L_stb_40
L_stg_41:
    global_store_dwordx4 v236, v[108:111], s[44:45] offset:3072 sc1
    s_branch L_stb_42
L_p3re_43:
    s_add_u32 s8, s8, 1
    s_cmp_ge_u32 s8, 262144
    s_cbranch_scc1 L_p3ok_44
    global_load_dword v238, v35, s[44:45] sc1
    s_waitcnt vmcnt(0)
    v_sub_u32 v238, v238, v3
    v_cmp_lt_u32 vcc, 1, v238
    s_cbranch_vccnz L_p3re_43
    s_branch L_p3ok_44
L_stg_48:
    global_store_dword v2, v237, s[44:45] sc1
    s_branch L_stb_49
L_p3re_51:
    s_add_u32 s8, s8, 1
    s_cmp_ge_u32 s8, 262144
    s_cbranch_scc1 L_p3ok_52
    global_load_dword v238, v35, s[44:45] sc1
    s_waitcnt vmcnt(0)
    v_cmp_ne_u32 vcc, v238, v237
    s_cbranch_vccnz L_p3re_51
    s_branch L_p3ok_52
L_CODE_END:
.section .rodata,"a"
.p2align 6
.amdhsa_kernel sequential_preLN__ssm_conv_s4__dense_activation_relu__prompt_kernel
  .amdhsa_next_free_vgpr 512
  .amdhsa_next_free_sgpr 102
  .amdhsa_accum_offset 256
  .amdhsa_group_segment_fixed_size 0
  .amdhsa_kernarg_size 120
  .amdhsa_user_sgpr_count 2
  .amdhsa_user_sgpr_kernarg_segment_ptr 1
  .amdhsa_system_sgpr_workgroup_id_x 1
.end_amdhsa_kernel
```
